```python
import torch

def _softmax(x, axis=-1):
    return torch.softmax(x, dim=axis)
def _gelu(x):
    return torch.nn.functional.gelu(x, approximate="tanh")
def _silu(x):
    return torch.nn.functional.silu(x)
def _sigmoid(x):
    return torch.sigmoid(x)
def _layernorm(x, axis=-1, eps=1e-5):
    m = x.mean(dim=axis, keepdim=True)
    v = x.var(dim=axis, keepdim=True, unbiased=False)
    return (x - m) / torch.sqrt(v + eps)
def _scatter_add(tgt, idx, src, axis=0):
    return tgt.clone().index_add_(axis, idx, src)
def _segment_sum(src, seg, n):
    out = torch.zeros((n,) + src.shape[1:], dtype=src.dtype)
    return out.index_add_(0, seg, src)
def _pad(x, pw):
    flat = tuple(v for pair in reversed(pw) for v in pair)
    return torch.nn.functional.pad(x, flat)

kernel_name = 'parallel_sum__mha_block_cached__dense_activation_silu__decode'

def setup_inputs():

    _w = (lambda a: (lambda t: t.to(torch.bfloat16) if t.is_floating_point() else t)(torch.as_tensor(a)))
    def _A_setup():
        B, Sq, D = 4, 1, 640
        H, Sk, Dh = 32, 8192, 192
        return {
            "x": _w((lambda *s: torch.randn(*s, dtype=torch.bfloat16) * 0.05)(B, Sq, D)),
            "k_cache": _w((lambda *s: torch.randn(*s, dtype=torch.bfloat16) * 3.2)(B, H, Sk, Dh)),
            "v_cache": _w((lambda *s: torch.randn(*s, dtype=torch.bfloat16) * 0.8)(B, H, Sk, Dh)),
            "wq": _w((lambda *s: torch.randn(*s, dtype=torch.bfloat16) * 3.2)(D, H * Dh) * (D ** -0.5)),
            "wo": _w((lambda *s: torch.randn(*s, dtype=torch.bfloat16) * 0.8)(H * Dh, D) * ((H * Dh) ** -0.5)),
        }
    _A_in = _A_setup()

    def _B_setup():
        B, S, D, F = 4, 1, 640, 1536
        return {
            "x": _w((lambda *s: torch.randn(*s, dtype=torch.bfloat16) * 0.05)(B, S, D)),
            "w1": _w((lambda *s: torch.randn(*s, dtype=torch.bfloat16) * 3.2)(D, F) * (D ** -0.5)),
            "w2": _w((lambda *s: torch.randn(*s, dtype=torch.bfloat16) * 0.4)(F, D) * (F ** -0.5)),
        }
    _B_in = _B_setup()

    return {
        "A_x": _A_in["x"],
        "A_k_cache": _A_in["k_cache"],
        "A_v_cache": _A_in["v_cache"],
        "A_wq": _A_in["wq"],
        "A_wo": _A_in["wo"],
        "B_x": _B_in["x"],
        "B_w1": _B_in["w1"],
        "B_w2": _B_in["w2"],
    }

def reference(A_x, A_k_cache, A_v_cache, A_wq, A_wo, B_x, B_w1, B_w2):
    def _A_ref(x, k_cache, v_cache, wq, wo):
        B, Sq, D = x.shape
        H, Dh = 32, 192
        q = (lambda x, *d: x.permute(*d))((x @ wq).reshape(B, Sq, H, Dh), 0, 2, 1, 3)
        scores = torch.einsum("bhqd,bhkd->bhqk", q, k_cache) * (Dh ** -0.5)
        p = _softmax(scores, axis=-1)
        o = torch.einsum("bhqk,bhkd->bhqd", p, v_cache)
        return (lambda x, *d: x.permute(*d))(o, 0, 2, 1, 3).reshape(B, Sq, H * Dh) @ wo

    def _B_ref(x, w1, w2):
        h = torch.einsum("bsd,df->bsf", x, w1)
        h = _silu(h)
        out = torch.einsum("bsf,fd->bsd", h, w2)
        return out

    x = A_x
    xn = _layernorm(x, axis=-1)
    return x + _A_ref(xn, A_k_cache, A_v_cache, A_wq, A_wo) + _B_ref(xn, B_w1, B_w2)
```

```asm
; @launch grid=(256,1,1) block=(512,1,1) lds=88064
.amdgcn_target "amdgcn-amd-amdhsa--gfx950"
.text
.globl parallel_sum__mha_block_cached__dense_activation_silu__decode_kernel
.p2align 8
.type parallel_sum__mha_block_cached__dense_activation_silu__decode_kernel,@function
parallel_sum__mha_block_cached__dense_activation_silu__decode_kernel:
    s_cmp_ge_u32 s2, 256
    s_cbranch_scc1 L_end
    s_load_dwordx16 s[4:19], s[0:1], 0
    s_load_dwordx4 s[20:23], s[0:1], 64
    s_load_dwordx2 s[24:25], s[0:1], 80
    v_lshrrev_b32 v2, 6, v0
    v_and_b32 v1, 63, v0
    v_readfirstlane_b32 s3, v2
    s_and_b32 s26, s2, 31
    s_lshr_b32 s27, s2, 5
    s_getpc_b64 s[86:87]
L_pc:
    v_lshlrev_b32 v14, 5, v0
    v_min_u32 v14, L_end-L_pc, v14
    global_load_dword v79, v14, s[86:87]
    s_cmp_lt_u32 s3, 4
    s_cbranch_scc1 L_stream
    s_sub_u32 s28, s3, 4
    s_and_b32 s70, s27, 4
    s_add_u32 s70, s70, s28
    s_and_b32 s89, s27, 3
    v_lshrrev_b32 v14, 4, v1
    v_and_b32 v15, 15, v1
    v_mul_u32_u24 v14, 1280, v14
    v_mad_u32_u24 v3, v15, 12, v14
    v_lshl_add_u32 v2, v15, 4, v14
    s_mul_i32 s65, s70, 160
    s_mov_b32 s34, 5120
    s_mov_b32 s35, 0x20000
    s_cmp_lt_u32 s26, 24
    s_cselect_b32 s66, 1966080, 0
    s_mul_i32 s67, s26, 384
    s_lshl_b32 s68, s89, 7
    s_add_u32 s67, s67, s68
    s_lshl_b32 s68, s26, 7
    s_cmp_lt_u32 s89, 3
    s_cselect_b32 s38, 7864320, s66
    s_mov_b32 s39, 0x20000
    s_cselect_b32 s67, s67, s68
    s_movk_i32 s68, 3072
    s_cselect_b32 s68, 0x3000, s68
    s_mul_i32 s69, s68, 10
    s_mul_i32 s70, s70, 80
    s_mul_i32 s70, s70, s68
    v_lshrrev_b32 v82, 3, v1
    v_and_b32 v83, 7, v1
    v_mul_lo_u32 v14, v82, s69
    v_lshl_add_u32 v12, v83, 4, v14
    s_waitcnt lgkmcnt(0)
    s_cselect_b32 s36, s10, s16
    s_cselect_b32 s37, s11, s17
    s_mov_b32 s32, s4
    s_mov_b32 s33, s5
    s_add_u32 s67, s67, s70
    s_load_dword s56, s[24:25], 0
    buffer_load_dwordx4 v[16:19], v2, s[32:35], 0 offen offset:0
    buffer_load_dwordx4 v[20:23], v2, s[32:35], 0 offen offset:256
    buffer_load_dwordx4 v[24:27], v2, s[32:35], 0 offen offset:512
    buffer_load_dwordx4 v[28:31], v2, s[32:35], 0 offen offset:768
    buffer_load_dwordx4 v[32:35], v2, s[32:35], 0 offen offset:1024
    buffer_load_dwordx3 v[76:78], v3, s[32:35], s65 offen
    buffer_load_dwordx4 v[84:87], v12, s[36:39], s67 offen nt
    s_add_u32 s67, s67, s68
    buffer_load_dwordx4 v[88:91], v12, s[36:39], s67 offen nt
    s_add_u32 s67, s67, s68
    buffer_load_dwordx4 v[92:95], v12, s[36:39], s67 offen nt
    s_add_u32 s67, s67, s68
    buffer_load_dwordx4 v[96:99], v12, s[36:39], s67 offen nt
    s_add_u32 s67, s67, s68
    buffer_load_dwordx4 v[100:103], v12, s[36:39], s67 offen nt
    s_add_u32 s67, s67, s68
    buffer_load_dwordx4 v[104:107], v12, s[36:39], s67 offen nt
    s_add_u32 s67, s67, s68
    buffer_load_dwordx4 v[108:111], v12, s[36:39], s67 offen nt
    s_add_u32 s67, s67, s68
    buffer_load_dwordx4 v[112:115], v12, s[36:39], s67 offen nt
    s_add_u32 s67, s67, s68
    buffer_load_dwordx4 v[116:119], v12, s[36:39], s67 offen nt
    s_add_u32 s67, s67, s68
    buffer_load_dwordx4 v[120:123], v12, s[36:39], s67 offen nt
    s_barrier
    v_and_b32 v14, 1, v1
    v_lshlrev_b32 v14, 4, v14
    v_mov_b32 v15, 0xffff
    v_lshlrev_b32 v14, v14, v15
    v_bfe_u32 v15, v1, 1, 2
    v_cmp_eq_u32 vcc, 0, v15
    s_nop 1
    v_cndmask_b32 v4, 0, v14, vcc
    v_cmp_eq_u32 vcc, 1, v15
    s_nop 1
    v_cndmask_b32 v5, 0, v14, vcc
    v_cmp_eq_u32 vcc, 2, v15
    s_nop 1
    v_cndmask_b32 v6, 0, v14, vcc
    v_cmp_eq_u32 vcc, 3, v15
    s_nop 1
    v_cndmask_b32 v7, 0, v14, vcc
    s_mov_b32 s48, s24
    s_mov_b32 s49, s25
    s_mov_b32 s50, 1769472
    s_mov_b32 s51, 0x20000
    s_mov_b32 s72, 0x3fb8aa3b
    v_mov_b32 v81, 0xffff0000
    s_waitcnt vmcnt(11)
    v_lshlrev_b32 v36, 16, v16
    v_and_b32 v37, v81, v16
    v_lshlrev_b32 v38, 16, v17
    v_and_b32 v39, v81, v17
    v_lshlrev_b32 v40, 16, v18
    v_and_b32 v41, v81, v18
    v_lshlrev_b32 v42, 16, v19
    v_and_b32 v43, v81, v19
    v_lshlrev_b32 v44, 16, v20
    v_and_b32 v45, v81, v20
    v_lshlrev_b32 v46, 16, v21
    v_and_b32 v47, v81, v21
    v_lshlrev_b32 v48, 16, v22
    v_and_b32 v49, v81, v22
    v_lshlrev_b32 v50, 16, v23
    v_and_b32 v51, v81, v23
    v_lshlrev_b32 v52, 16, v24
    v_and_b32 v53, v81, v24
    v_lshlrev_b32 v54, 16, v25
    v_and_b32 v55, v81, v25
    v_lshlrev_b32 v56, 16, v26
    v_and_b32 v57, v81, v26
    v_lshlrev_b32 v58, 16, v27
    v_and_b32 v59, v81, v27
    v_lshlrev_b32 v60, 16, v28
    v_and_b32 v61, v81, v28
    v_lshlrev_b32 v62, 16, v29
    v_and_b32 v63, v81, v29
    v_lshlrev_b32 v64, 16, v30
    v_and_b32 v65, v81, v30
    v_lshlrev_b32 v66, 16, v31
    v_and_b32 v67, v81, v31
    v_lshlrev_b32 v68, 16, v32
    v_and_b32 v69, v81, v32
    v_lshlrev_b32 v70, 16, v33
    v_and_b32 v71, v81, v33
    v_lshlrev_b32 v72, 16, v34
    v_and_b32 v73, v81, v34
    v_lshlrev_b32 v74, 16, v35
    v_and_b32 v75, v81, v35
    v_add_f32 v8, v36, v37
    v_add_f32 v9, v38, v39
    v_add_f32 v8, v8, v40
    v_add_f32 v9, v9, v41
    v_add_f32 v8, v8, v42
    v_add_f32 v9, v9, v43
    v_add_f32 v8, v8, v44
    v_add_f32 v9, v9, v45
    v_add_f32 v8, v8, v46
    v_add_f32 v9, v9, v47
    v_add_f32 v8, v8, v48
    v_add_f32 v9, v9, v49
    v_add_f32 v8, v8, v50
    v_add_f32 v9, v9, v51
    v_add_f32 v8, v8, v52
    v_add_f32 v9, v9, v53
    v_add_f32 v8, v8, v54
    v_add_f32 v9, v9, v55
    v_add_f32 v8, v8, v56
    v_add_f32 v9, v9, v57
    v_add_f32 v8, v8, v58
    v_add_f32 v9, v9, v59
    v_add_f32 v8, v8, v60
    v_add_f32 v9, v9, v61
    v_add_f32 v8, v8, v62
    v_add_f32 v9, v9, v63
    v_add_f32 v8, v8, v64
    v_add_f32 v9, v9, v65
    v_add_f32 v8, v8, v66
    v_add_f32 v9, v9, v67
    v_add_f32 v8, v8, v68
    v_add_f32 v9, v9, v69
    v_add_f32 v8, v8, v70
    v_add_f32 v9, v9, v71
    v_add_f32 v8, v8, v72
    v_add_f32 v9, v9, v73
    v_add_f32 v8, v8, v74
    v_add_f32 v9, v9, v75
    v_add_f32 v8, v8, v9
    s_nop 1
    v_add_f32_dpp v8, v8, v8 row_ror:8 row_mask:0xf bank_mask:0xf
    s_nop 1
    v_add_f32_dpp v8, v8, v8 row_ror:4 row_mask:0xf bank_mask:0xf
    s_nop 1
    v_add_f32_dpp v8, v8, v8 row_ror:2 row_mask:0xf bank_mask:0xf
    s_nop 1
    v_add_f32_dpp v8, v8, v8 row_ror:1 row_mask:0xf bank_mask:0xf
    v_mul_f32 v8, 0x3acccccd, v8
    v_sub_f32 v36, v36, v8
    v_sub_f32 v37, v37, v8
    v_sub_f32 v38, v38, v8
    v_sub_f32 v39, v39, v8
    v_sub_f32 v40, v40, v8
    v_sub_f32 v41, v41, v8
    v_sub_f32 v42, v42, v8
    v_sub_f32 v43, v43, v8
    v_sub_f32 v44, v44, v8
    v_sub_f32 v45, v45, v8
    v_sub_f32 v46, v46, v8
    v_sub_f32 v47, v47, v8
    v_sub_f32 v48, v48, v8
    v_sub_f32 v49, v49, v8
    v_sub_f32 v50, v50, v8
    v_sub_f32 v51, v51, v8
    v_sub_f32 v52, v52, v8
    v_sub_f32 v53, v53, v8
    v_sub_f32 v54, v54, v8
    v_sub_f32 v55, v55, v8
    v_sub_f32 v56, v56, v8
    v_sub_f32 v57, v57, v8
    v_sub_f32 v58, v58, v8
    v_sub_f32 v59, v59, v8
    v_sub_f32 v60, v60, v8
    v_sub_f32 v61, v61, v8
    v_sub_f32 v62, v62, v8
    v_sub_f32 v63, v63, v8
    v_sub_f32 v64, v64, v8
    v_sub_f32 v65, v65, v8
    v_sub_f32 v66, v66, v8
    v_sub_f32 v67, v67, v8
    v_sub_f32 v68, v68, v8
    v_sub_f32 v69, v69, v8
    v_sub_f32 v70, v70, v8
    v_sub_f32 v71, v71, v8
    v_sub_f32 v72, v72, v8
    v_sub_f32 v73, v73, v8
    v_sub_f32 v74, v74, v8
    v_sub_f32 v75, v75, v8
    v_mul_f32 v9, v36, v36
    v_mul_f32 v10, v37, v37
    v_fmac_f32 v9, v38, v38
    v_fmac_f32 v10, v39, v39
    v_fmac_f32 v9, v40, v40
    v_fmac_f32 v10, v41, v41
    v_fmac_f32 v9, v42, v42
    v_fmac_f32 v10, v43, v43
    v_fmac_f32 v9, v44, v44
    v_fmac_f32 v10, v45, v45
    v_fmac_f32 v9, v46, v46
    v_fmac_f32 v10, v47, v47
    v_fmac_f32 v9, v48, v48
    v_fmac_f32 v10, v49, v49
    v_fmac_f32 v9, v50, v50
    v_fmac_f32 v10, v51, v51
    v_fmac_f32 v9, v52, v52
    v_fmac_f32 v10, v53, v53
    v_fmac_f32 v9, v54, v54
    v_fmac_f32 v10, v55, v55
    v_fmac_f32 v9, v56, v56
    v_fmac_f32 v10, v57, v57
    v_fmac_f32 v9, v58, v58
    v_fmac_f32 v10, v59, v59
    v_fmac_f32 v9, v60, v60
    v_fmac_f32 v10, v61, v61
    v_fmac_f32 v9, v62, v62
    v_fmac_f32 v10, v63, v63
    v_fmac_f32 v9, v64, v64
    v_fmac_f32 v10, v65, v65
    v_fmac_f32 v9, v66, v66
    v_fmac_f32 v10, v67, v67
    v_fmac_f32 v9, v68, v68
    v_fmac_f32 v10, v69, v69
    v_fmac_f32 v9, v70, v70
    v_fmac_f32 v10, v71, v71
    v_fmac_f32 v9, v72, v72
    v_fmac_f32 v10, v73, v73
    v_fmac_f32 v9, v74, v74
    v_fmac_f32 v10, v75, v75
    v_add_f32 v9, v9, v10
    s_nop 1
    v_add_f32_dpp v9, v9, v9 row_ror:8 row_mask:0xf bank_mask:0xf
    s_nop 1
    v_add_f32_dpp v9, v9, v9 row_ror:4 row_mask:0xf bank_mask:0xf
    s_nop 1
    v_add_f32_dpp v9, v9, v9 row_ror:2 row_mask:0xf bank_mask:0xf
    s_nop 1
    v_add_f32_dpp v9, v9, v9 row_ror:1 row_mask:0xf bank_mask:0xf
    v_mul_f32 v9, 0x3acccccd, v9
    v_cvt_pk_bf16_f32 v9, v8, v9
    v_lshlrev_b32 v8, 16, v9
    v_and_b32 v9, v81, v9
    v_add_f32 v9, 0x3727c5ac, v9
    v_cvt_pk_bf16_f32 v9, v9, v9
    v_and_b32 v9, v81, v9
    v_sqrt_f32 v9, v9
    v_lshrrev_b32 v14, 4, v1
    v_cvt_pk_bf16_f32 v9, v9, v9
    v_and_b32 v9, v81, v9
    v_rcp_f32 v9, v9
    v_mul_u32_u24 v14, 384, v14
    v_and_b32 v15, 15, v1
    v_mad_u32_u24 v14, v15, 24, v14
    s_mul_i32 s65, s28, 1536
    s_add_u32 s65, s65, 3840
    v_add_u32 v14, s65, v14
    v_mad_u32_u24 v15, v82, 40, s65
    s_waitcnt vmcnt(10)
    v_lshlrev_b32 v16, 16, v76
    v_and_b32 v17, v81, v76
    v_lshlrev_b32 v18, 16, v77
    v_and_b32 v19, v81, v77
    v_lshlrev_b32 v20, 16, v78
    v_and_b32 v21, v81, v78
    v_sub_f32 v16, v16, v8
    v_sub_f32 v17, v17, v8
    v_sub_f32 v18, v18, v8
    v_sub_f32 v19, v19, v8
    v_sub_f32 v20, v20, v8
    v_sub_f32 v21, v21, v8
    v_cvt_pk_bf16_f32 v76, v16, v17
    v_cvt_pk_bf16_f32 v77, v18, v19
    v_cvt_pk_bf16_f32 v78, v20, v21
    v_lshlrev_b32 v16, 16, v76
    v_and_b32 v17, v81, v76
    v_lshlrev_b32 v18, 16, v77
    v_and_b32 v19, v81, v77
    v_lshlrev_b32 v20, 16, v78
    v_and_b32 v21, v81, v78
    v_mul_f32 v16, v16, v9
    v_mul_f32 v17, v17, v9
    v_mul_f32 v18, v18, v9
    v_mul_f32 v19, v19, v9
    v_mul_f32 v20, v20, v9
    v_mul_f32 v21, v21, v9
    v_cvt_pk_bf16_f32 v16, v16, v16
    v_cvt_pk_bf16_f32 v17, v17, v17
    v_cvt_pk_bf16_f32 v18, v18, v18
    v_cvt_pk_bf16_f32 v19, v19, v19
    v_cvt_pk_bf16_f32 v20, v20, v20
    v_cvt_pk_bf16_f32 v21, v21, v21
    ds_write_b64 v14, v[16:17] offset:0
    ds_write_b64 v14, v[18:19] offset:8
    ds_write_b64 v14, v[20:21] offset:16
    s_waitcnt lgkmcnt(0)
    ds_read2_b64 v[36:39], v15 offset0:0 offset1:1
    ds_read2_b64 v[40:43], v15 offset0:2 offset1:3
    ds_read_b64 v[44:45], v15 offset:32
    ds_read2_b64 v[46:49], v15 offset0:48 offset1:49
    ds_read2_b64 v[50:53], v15 offset0:50 offset1:51
    ds_read_b64 v[54:55], v15 offset:416
    ds_read2_b64 v[56:59], v15 offset0:96 offset1:97
    ds_read2_b64 v[60:63], v15 offset0:98 offset1:99
    ds_read_b64 v[64:65], v15 offset:800
    ds_read2_b64 v[66:69], v15 offset0:144 offset1:145
    ds_read2_b64 v[70:73], v15 offset0:146 offset1:147
    ds_read_b64 v[74:75], v15 offset:1184
    s_add_u32 s56, s56, 0x11111111
    s_bfe_u32 s57, s56, 524288
    s_bfe_u32 s61, s56, 262144
    s_bfe_u32 s58, s56, 524296
    s_bfe_u32 s62, s56, 262148
    s_bfe_u32 s59, s56, 524304
    s_bfe_u32 s63, s56, 262152
    s_bfe_u32 s60, s56, 524312
    s_bfe_u32 s64, s56, 262156
    s_lshl_b32 s65, s26, 2
    s_add_u32 s65, s65, s28
    s_lshl_b32 s65, s65, 11
    s_add_u32 s65, s65, 4096
    s_lshl_b32 s67, s27, 8
    s_add_u32 s67, s67, s65
    s_mul_i32 s76, s26, 6
    s_add_u32 s76, s76, s28
    s_lshl_b32 s76, s76, 11
    s_add_u32 s76, s76, 393216
    s_lshl_b32 s77, s27, 8
    s_add_u32 s77, s77, s76
    s_getreg_b32 s74, hwreg(HW_REG_XCC_ID, 0, 4)
    s_xor_b32 s75, s63, s74
    v_lshlrev_b32 v76, 4, v1
    v_mov_b32 v3, 0xfffffff0
    v_lshrrev_b32 v77, 5, v1
    v_bfe_u32 v78, v1, 3, 1
    v_lshl_add_u32 v77, v78, 1, v77
    v_bfe_u32 v78, v1, 4, 1
    v_lshl_add_u32 v78, v83, 1, v78
    v_lshlrev_b32 v78, 4, v78
    v_lshl_add_u32 v77, v77, 8, v78
    s_lshl_b32 s68, s28, 10
    v_add_u32 v77, s68, v77
    v_and_b32 v78, 15, v1
    s_lshl_b32 s68, s28, 8
    v_lshl_add_u32 v78, v78, 4, s68
    s_waitcnt lgkmcnt(0)
    v_and_b32 v8, v36, v4
    v_and_b32 v9, v36, v5
    v_and_b32 v10, v36, v6
    v_and_b32 v11, v36, v7
    v_and_b32 v12, v46, v4
    v_and_b32 v13, v46, v5
    v_and_b32 v14, v46, v6
    v_and_b32 v15, v46, v7
    s_waitcnt vmcnt(9)
    v_mfma_f32_16x16x32_bf16 v[16:19], v[8:11], v[84:87], 0
    v_and_b32 v8, v56, v4
    v_and_b32 v9, v56, v5
    v_and_b32 v10, v56, v6
    v_and_b32 v11, v56, v7
    v_mfma_f32_16x16x32_bf16 v[20:23], v[12:15], v[84:87], 0
    v_and_b32 v12, v66, v4
    v_and_b32 v13, v66, v5
    v_and_b32 v14, v66, v6
    v_and_b32 v15, v66, v7
    v_mfma_f32_16x16x32_bf16 v[24:27], v[8:11], v[84:87], 0
    v_and_b32 v8, v37, v4
    v_and_b32 v9, v37, v5
    v_and_b32 v10, v37, v6
    v_and_b32 v11, v37, v7
    v_mfma_f32_16x16x32_bf16 v[28:31], v[12:15], v[84:87], 0
    v_and_b32 v12, v47, v4
    v_and_b32 v13, v47, v5
    v_and_b32 v14, v47, v6
    v_and_b32 v15, v47, v7
    s_waitcnt vmcnt(8)
    v_mfma_f32_16x16x32_bf16 v[16:19], v[8:11], v[88:91], v[16:19]
    v_and_b32 v8, v57, v4
    v_and_b32 v9, v57, v5
    v_and_b32 v10, v57, v6
    v_and_b32 v11, v57, v7
    v_mfma_f32_16x16x32_bf16 v[20:23], v[12:15], v[88:91], v[20:23]
    v_and_b32 v12, v67, v4
    v_and_b32 v13, v67, v5
    v_and_b32 v14, v67, v6
    v_and_b32 v15, v67, v7
    v_mfma_f32_16x16x32_bf16 v[24:27], v[8:11], v[88:91], v[24:27]
    v_and_b32 v8, v38, v4
    v_and_b32 v9, v38, v5
    v_and_b32 v10, v38, v6
    v_and_b32 v11, v38, v7
    v_mfma_f32_16x16x32_bf16 v[28:31], v[12:15], v[88:91], v[28:31]
    v_and_b32 v12, v48, v4
    v_and_b32 v13, v48, v5
    v_and_b32 v14, v48, v6
    v_and_b32 v15, v48, v7
    s_waitcnt vmcnt(7)
    v_mfma_f32_16x16x32_bf16 v[16:19], v[8:11], v[92:95], v[16:19]
    v_and_b32 v8, v58, v4
    v_and_b32 v9, v58, v5
    v_and_b32 v10, v58, v6
    v_and_b32 v11, v58, v7
    v_mfma_f32_16x16x32_bf16 v[20:23], v[12:15], v[92:95], v[20:23]
    v_and_b32 v12, v68, v4
    v_and_b32 v13, v68, v5
    v_and_b32 v14, v68, v6
    v_and_b32 v15, v68, v7
    v_mfma_f32_16x16x32_bf16 v[24:27], v[8:11], v[92:95], v[24:27]
    v_and_b32 v8, v39, v4
    v_and_b32 v9, v39, v5
    v_and_b32 v10, v39, v6
    v_and_b32 v11, v39, v7
    v_mfma_f32_16x16x32_bf16 v[28:31], v[12:15], v[92:95], v[28:31]
    v_and_b32 v12, v49, v4
    v_and_b32 v13, v49, v5
    v_and_b32 v14, v49, v6
    v_and_b32 v15, v49, v7
    s_waitcnt vmcnt(6)
    v_mfma_f32_16x16x32_bf16 v[16:19], v[8:11], v[96:99], v[16:19]
    v_and_b32 v8, v59, v4
    v_and_b32 v9, v59, v5
    v_and_b32 v10, v59, v6
    v_and_b32 v11, v59, v7
    v_mfma_f32_16x16x32_bf16 v[20:23], v[12:15], v[96:99], v[20:23]
    v_and_b32 v12, v69, v4
    v_and_b32 v13, v69, v5
    v_and_b32 v14, v69, v6
    v_and_b32 v15, v69, v7
    v_mfma_f32_16x16x32_bf16 v[24:27], v[8:11], v[96:99], v[24:27]
    v_and_b32 v8, v40, v4
    v_and_b32 v9, v40, v5
    v_and_b32 v10, v40, v6
    v_and_b32 v11, v40, v7
    v_mfma_f32_16x16x32_bf16 v[28:31], v[12:15], v[96:99], v[28:31]
    v_and_b32 v12, v50, v4
    v_and_b32 v13, v50, v5
    v_and_b32 v14, v50, v6
    v_and_b32 v15, v50, v7
    s_waitcnt vmcnt(5)
    v_mfma_f32_16x16x32_bf16 v[16:19], v[8:11], v[100:103], v[16:19]
    v_and_b32 v8, v60, v4
    v_and_b32 v9, v60, v5
    v_and_b32 v10, v60, v6
    v_and_b32 v11, v60, v7
    v_mfma_f32_16x16x32_bf16 v[20:23], v[12:15], v[100:103], v[20:23]
    v_and_b32 v12, v70, v4
    v_and_b32 v13, v70, v5
    v_and_b32 v14, v70, v6
    v_and_b32 v15, v70, v7
    v_mfma_f32_16x16x32_bf16 v[24:27], v[8:11], v[100:103], v[24:27]
    v_and_b32 v8, v41, v4
    v_and_b32 v9, v41, v5
    v_and_b32 v10, v41, v6
    v_and_b32 v11, v41, v7
    v_mfma_f32_16x16x32_bf16 v[28:31], v[12:15], v[100:103], v[28:31]
    v_and_b32 v12, v51, v4
    v_and_b32 v13, v51, v5
    v_and_b32 v14, v51, v6
    v_and_b32 v15, v51, v7
    s_waitcnt vmcnt(4)
    v_mfma_f32_16x16x32_bf16 v[16:19], v[8:11], v[104:107], v[16:19]
    v_and_b32 v8, v61, v4
    v_and_b32 v9, v61, v5
    v_and_b32 v10, v61, v6
    v_and_b32 v11, v61, v7
    v_mfma_f32_16x16x32_bf16 v[20:23], v[12:15], v[104:107], v[20:23]
    v_and_b32 v12, v71, v4
    v_and_b32 v13, v71, v5
    v_and_b32 v14, v71, v6
    v_and_b32 v15, v71, v7
    v_mfma_f32_16x16x32_bf16 v[24:27], v[8:11], v[104:107], v[24:27]
    v_and_b32 v8, v42, v4
    v_and_b32 v9, v42, v5
    v_and_b32 v10, v42, v6
    v_and_b32 v11, v42, v7
    v_mfma_f32_16x16x32_bf16 v[28:31], v[12:15], v[104:107], v[28:31]
    v_and_b32 v12, v52, v4
    v_and_b32 v13, v52, v5
    v_and_b32 v14, v52, v6
    v_and_b32 v15, v52, v7
    s_waitcnt vmcnt(3)
    v_mfma_f32_16x16x32_bf16 v[16:19], v[8:11], v[108:111], v[16:19]
    v_and_b32 v8, v62, v4
    v_and_b32 v9, v62, v5
    v_and_b32 v10, v62, v6
    v_and_b32 v11, v62, v7
    v_mfma_f32_16x16x32_bf16 v[20:23], v[12:15], v[108:111], v[20:23]
    v_and_b32 v12, v72, v4
    v_and_b32 v13, v72, v5
    v_and_b32 v14, v72, v6
    v_and_b32 v15, v72, v7
    v_mfma_f32_16x16x32_bf16 v[24:27], v[8:11], v[108:111], v[24:27]
    v_and_b32 v8, v43, v4
    v_and_b32 v9, v43, v5
    v_and_b32 v10, v43, v6
    v_and_b32 v11, v43, v7
    v_mfma_f32_16x16x32_bf16 v[28:31], v[12:15], v[108:111], v[28:31]
    v_and_b32 v12, v53, v4
    v_and_b32 v13, v53, v5
    v_and_b32 v14, v53, v6
    v_and_b32 v15, v53, v7
    s_waitcnt vmcnt(2)
    v_mfma_f32_16x16x32_bf16 v[16:19], v[8:11], v[112:115], v[16:19]
    v_and_b32 v8, v63, v4
    v_and_b32 v9, v63, v5
    v_and_b32 v10, v63, v6
    v_and_b32 v11, v63, v7
    v_mfma_f32_16x16x32_bf16 v[20:23], v[12:15], v[112:115], v[20:23]
    v_and_b32 v12, v73, v4
    v_and_b32 v13, v73, v5
    v_and_b32 v14, v73, v6
    v_and_b32 v15, v73, v7
    v_mfma_f32_16x16x32_bf16 v[24:27], v[8:11], v[112:115], v[24:27]
    v_and_b32 v8, v44, v4
    v_and_b32 v9, v44, v5
    v_and_b32 v10, v44, v6
    v_and_b32 v11, v44, v7
    v_mfma_f32_16x16x32_bf16 v[28:31], v[12:15], v[112:115], v[28:31]
    v_and_b32 v12, v54, v4
    v_and_b32 v13, v54, v5
    v_and_b32 v14, v54, v6
    v_and_b32 v15, v54, v7
    s_waitcnt vmcnt(1)
    v_mfma_f32_16x16x32_bf16 v[16:19], v[8:11], v[116:119], v[16:19]
    v_and_b32 v8, v64, v4
    v_and_b32 v9, v64, v5
    v_and_b32 v10, v64, v6
    v_and_b32 v11, v64, v7
    v_mfma_f32_16x16x32_bf16 v[20:23], v[12:15], v[116:119], v[20:23]
    v_and_b32 v12, v74, v4
    v_and_b32 v13, v74, v5
    v_and_b32 v14, v74, v6
    v_and_b32 v15, v74, v7
    v_mfma_f32_16x16x32_bf16 v[24:27], v[8:11], v[116:119], v[24:27]
    v_and_b32 v8, v45, v4
    v_and_b32 v9, v45, v5
    v_and_b32 v10, v45, v6
    v_and_b32 v11, v45, v7
    v_mfma_f32_16x16x32_bf16 v[28:31], v[12:15], v[116:119], v[28:31]
    v_and_b32 v12, v55, v4
    v_and_b32 v13, v55, v5
    v_and_b32 v14, v55, v6
    v_and_b32 v15, v55, v7
    s_waitcnt vmcnt(0)
    v_mfma_f32_16x16x32_bf16 v[16:19], v[8:11], v[120:123], v[16:19]
    v_and_b32 v8, v65, v4
    v_and_b32 v9, v65, v5
    v_and_b32 v10, v65, v6
    v_and_b32 v11, v65, v7
    v_mfma_f32_16x16x32_bf16 v[20:23], v[12:15], v[120:123], v[20:23]
    v_and_b32 v12, v75, v4
    v_and_b32 v13, v75, v5
    v_and_b32 v14, v75, v6
    v_and_b32 v15, v75, v7
    v_mfma_f32_16x16x32_bf16 v[24:27], v[8:11], v[120:123], v[24:27]
    s_nop 0
    v_mfma_f32_16x16x32_bf16 v[28:31], v[12:15], v[120:123], v[28:31]
    s_nop 0
    v_permlane32_swap_b32 v16, v20
    v_permlane32_swap_b32 v17, v21
    v_permlane32_swap_b32 v18, v22
    v_permlane32_swap_b32 v19, v23
    s_nop 2
    v_permlane32_swap_b32 v24, v28
    v_permlane32_swap_b32 v25, v29
    v_permlane32_swap_b32 v26, v30
    v_permlane32_swap_b32 v27, v31
    v_add_f32_dpp v8, v20, v16 row_ror:8 row_mask:0xf bank_mask:0x3
    v_add_f32_dpp v9, v21, v17 row_ror:8 row_mask:0xf bank_mask:0x3
    v_add_f32_dpp v10, v22, v18 row_ror:8 row_mask:0xf bank_mask:0x3
    v_add_f32_dpp v11, v23, v19 row_ror:8 row_mask:0xf bank_mask:0x3
    v_add_f32_dpp v8, v24, v28 row_ror:8 row_mask:0xf bank_mask:0xc
    v_add_f32_dpp v9, v25, v29 row_ror:8 row_mask:0xf bank_mask:0xc
    v_add_f32_dpp v10, v26, v30 row_ror:8 row_mask:0xf bank_mask:0xc
    v_add_f32_dpp v11, v27, v31 row_ror:8 row_mask:0xf bank_mask:0xc
    ds_write_b128 v77, v[8:11] offset:10240
    s_waitcnt lgkmcnt(0)
    s_barrier
    ds_read_b128 v[16:19], v78 offset:10240
    ds_read_b128 v[20:23], v78 offset:11264
    ds_read_b128 v[24:27], v78 offset:12288
    ds_read_b128 v[28:31], v78 offset:13312
    s_waitcnt lgkmcnt(0)
    v_add_f32 v16, v16, v24
    v_add_f32 v17, v17, v25
    v_add_f32 v18, v18, v26
    v_add_f32 v19, v19, v27
    v_add_f32 v20, v20, v28
    v_add_f32 v21, v21, v29
    v_add_f32 v22, v22, v30
    v_add_f32 v23, v23, v31
    v_add_f32 v16, v16, v20
    v_add_f32 v17, v17, v21
    v_add_f32 v18, v18, v22
    v_add_f32 v19, v19, v23
    v_and_or_b32 v8, v16, v3, s61
    v_and_or_b32 v9, v17, v3, s62
    v_and_or_b32 v10, v18, v3, s75
    v_and_or_b32 v11, v19, v3, s64
    s_mov_b64 exec, 0xffff
    buffer_store_dwordx4 v[8:11], v76, s[48:51], s77 offen
    s_mov_b64 exec, -1
    s_mov_b32 s68, 262144
L_pollq:
    buffer_load_dwordx4 v[16:19], v76, s[48:51], s76 offen nt
    buffer_load_dwordx4 v[20:23], v76, s[48:51], s76 offen offset:1024 nt
    s_waitcnt vmcnt(0)
    v_xor_b32 v16, s61, v16
    v_xor_b32 v17, s62, v17
    v_xor_b32 v18, s75, v18
    v_xor_b32 v19, s64, v19
    v_or3_b32 v12, v16, v17, v18
    v_or_b32 v12, v12, v19
    v_xor_b32 v20, s61, v20
    v_xor_b32 v21, s62, v21
    v_xor_b32 v22, s75, v22
    v_xor_b32 v23, s64, v23
    v_or3_b32 v12, v12, v20, v21
    v_or3_b32 v12, v12, v22, v23
    v_and_b32 v12, 15, v12
    v_cmp_ne_u32 vcc, 0, v12
    s_cbranch_vccz L_gotq
    s_sleep 8
    s_sub_u32 s68, s68, 1
    s_cmp_gt_u32 s68, 262132
    s_cbranch_scc1 L_pollq
    s_cmp_lg_u32 s68, 262132
    s_cbranch_scc1 L_pollq1
    v_xor_b32 v10, s74, v10
    s_mov_b64 exec, 0xffff
    buffer_store_dwordx4 v[8:11], v76, s[48:51], s67 offen sc1
    s_mov_b64 exec, -1
L_pollq1:
    buffer_load_dwordx4 v[16:19], v76, s[48:51], s65 offen sc1
    buffer_load_dwordx4 v[20:23], v76, s[48:51], s65 offen offset:1024 sc1
    s_waitcnt vmcnt(0)
    v_xor_b32 v16, s61, v16
    v_xor_b32 v17, s62, v17
    v_xor_b32 v18, s63, v18
    v_xor_b32 v19, s64, v19
    v_or3_b32 v12, v16, v17, v18
    v_or_b32 v12, v12, v19
    v_xor_b32 v20, s61, v20
    v_xor_b32 v21, s62, v21
    v_xor_b32 v22, s63, v22
    v_xor_b32 v23, s64, v23
    v_or3_b32 v12, v12, v20, v21
    v_or3_b32 v12, v12, v22, v23
    v_and_b32 v12, 15, v12
    v_cmp_ne_u32 vcc, 0, v12
    s_cbranch_vccz L_gotq
    s_cmp_lg_u32 s68, 0
    s_cbranch_scc1 L_pollq
L_gotq:
    v_add_f32 v16, v16, v20
    v_add_f32 v17, v17, v21
    v_add_f32 v18, v18, v22
    v_add_f32 v19, v19, v23
    v_cvt_pk_bf16_f32 v8, v16, v17
    v_cvt_pk_bf16_f32 v9, v18, v19
    s_mul_i32 s65, s28, 384
    v_lshl_add_u32 v14, v1, 3, s65
    s_mov_b32 s80, -1
    s_mov_b32 s81, 0xffff
    s_mov_b64 exec, s[80:81]
    ds_write_b64 v14, v[8:9] offset:0
    s_mov_b64 exec, -1
    s_waitcnt lgkmcnt(0)
    s_barrier
    v_lshlrev_b32 v16, 16, v8
    v_and_b32 v17, v81, v8
    v_lshlrev_b32 v18, 16, v9
    v_and_b32 v19, v81, v9
    v_mul_f32 v8, s72, v16
    v_exp_f32 v8, -v8
    v_mul_f32 v9, s72, v17
    v_exp_f32 v9, -v9
    v_mul_f32 v10, s72, v18
    v_exp_f32 v10, -v10
    v_mul_f32 v11, s72, v19
    v_exp_f32 v11, -v11
    v_add_f32 v8, 1.0, v8
    v_rcp_f32 v8, v8
    v_add_f32 v9, 1.0, v9
    v_rcp_f32 v9, v9
    v_add_f32 v10, 1.0, v10
    v_rcp_f32 v10, v10
    v_add_f32 v11, 1.0, v11
    v_rcp_f32 v11, v11
    v_mul_f32 v8, v8, v16
    v_mul_f32 v9, v9, v17
    v_mul_f32 v10, v10, v18
    v_mul_f32 v11, v11, v19
    v_cvt_pk_bf16_f32 v8, v8, v9
    v_cvt_pk_bf16_f32 v9, v10, v11
    v_and_b32 v15, 3, v1
    v_bfe_u32 v14, v1, 2, 1
    v_lshl_add_u32 v15, v15, 1, v14
    v_and_b32 v14, 0x38, v1
    v_or_b32 v14, v14, v15
    s_mul_i32 s65, s28, 544
    v_lshl_add_u32 v14, v14, 3, s65
    s_andn2_b64 exec, exec, s[80:81]
    ds_write_b64 v14, v[8:9] offset:1536
    s_mov_b64 exec, -1
    v_mov_b32 v3, 0xffffff00
    s_cmp_lg_u32 s28, 3
    s_cbranch_scc1 L_gath
    s_lshr_b32 s65, s2, 3
    s_cmp_lg_u32 s65, 12
    s_cbranch_scc1 L_noco
    s_lshl_b32 s70, s56, 12
    s_and_b32 s71, s2, 7
    s_lshl_b32 s71, s71, 12
    s_add_u32 s71, s71, 1507328
    s_and_b32 s65, s2, 7
    s_lshl_b32 s65, s65, 8
    v_mov_b32 v12, s65
    v_mov_b32 v13, 512
    v_lshlrev_b32 v14, 3, v1
    v_mov_b32 v15, s56
    s_add_u32 s30, s24, 1572864
    s_addc_u32 s31, s25, 0
    s_mov_b32 s74, 1572864
    s_mov_b32 s75, 1024
    s_mov_b32 s76, 1472
    s_mov_b32 s68, 262144
L_co:
    buffer_load_dwordx2 v[8:9], v14, s[48:51], s71 offen nt
    s_waitcnt vmcnt(0)
    v_subrev_u32 v8, s70, v8
    v_subrev_u32 v9, s70, v9
    v_cmp_gt_u32 vcc, 0x200, v8
    s_nop 1
    v_cndmask_b32 v8, 0, v8, vcc
    v_cmp_gt_u32 vcc, 0x200, v9
    s_nop 1
    v_cndmask_b32 v9, 0, v9, vcc
    v_readlane_b32 s77, v8, 24
    v_add_u32 v8, v8, v9
    s_nop 1
    v_add_u32_dpp v8, v8, v8 row_ror:8 row_mask:0xf bank_mask:0xf
    s_nop 1
    v_add_u32_dpp v8, v8, v8 row_ror:4 row_mask:0xf bank_mask:0xf
    s_nop 1
    v_add_u32_dpp v8, v8, v8 row_ror:2 row_mask:0xf bank_mask:0xf
    s_nop 1
    v_add_u32_dpp v8, v8, v8 row_ror:1 row_mask:0xf bank_mask:0xf
    s_nop 0
    v_readlane_b32 s65, v8, 0
    v_readlane_b32 s66, v8, 16
    s_add_u32 s65, s65, s66
    v_readlane_b32 s66, v8, 32
    s_add_u32 s65, s65, s66
    v_readlane_b32 s66, v8, 48
    s_add_u32 s65, s65, s66
    s_cmp_lt_u32 s65, s75
    s_cbranch_scc1 L_co1
    s_mov_b64 exec, 1
    buffer_store_dword v15, v12, s[48:51], s74 offen sc1
    s_mov_b64 exec, -1
    s_add_u32 s74, s74, 2048
    s_add_u32 s75, s75, 1024
L_co1:
    s_cmp_lt_u32 s65, s76
    s_cbranch_scc1 L_co2
    s_load_dword s80, s[30:31], 0
    s_load_dword s81, s[30:31], 256
    s_load_dword s82, s[30:31], 512
    s_load_dword s83, s[30:31], 768
    s_load_dword s84, s[30:31], 1024
    s_load_dword s85, s[30:31], 1280
    s_load_dword s86, s[30:31], 1536
    s_load_dword s87, s[30:31], 1792
    s_add_u32 s76, s76, 1024
    s_movk_i32 s66, 0x400
    s_waitcnt lgkmcnt(0)
    s_add_u32 s30, s30, 2048
    s_addc_u32 s31, s31, 0
    s_cmp_lg_u32 s80, s56
    s_cselect_b32 s66, 1280, s66
    s_cmp_lg_u32 s81, s56
    s_cselect_b32 s66, 1280, s66
    s_cmp_lg_u32 s82, s56
    s_cselect_b32 s66, 1280, s66
    s_cmp_lg_u32 s83, s56
    s_cselect_b32 s66, 1280, s66
    s_cmp_lg_u32 s84, s56
    s_cselect_b32 s66, 1280, s66
    s_cmp_lg_u32 s85, s56
    s_cselect_b32 s66, 1280, s66
    s_cmp_lg_u32 s86, s56
    s_cselect_b32 s66, 1280, s66
    s_cmp_lg_u32 s87, s56
    s_cselect_b32 s66, 1280, s66
    s_add_u32 s66, s66, s70
    v_mov_b32 v10, s66
    s_mov_b64 exec, 1
    buffer_store_dword v10, v13, s[48:51], s71 offen
    s_mov_b64 exec, -1
L_co2:
    s_sub_u32 s68, s68, 1
    s_cmp_eq_u32 s68, 0
    s_cbranch_scc1 L_noco
    s_cmp_lt_u32 s77, 236
    s_cbranch_scc1 L_co
L_noco:
    s_mov_b32 s76, s12
    s_mov_b32 s77, s13
    s_mov_b32 s78, 7864320
    s_mov_b32 s79, 0x20000
    s_mul_i32 s85, s26, 81920
    s_mul_i32 s84, s85, 3
    v_lshrrev_b32 v14, 3, v1
    v_mul_u32_u24 v60, 1280, v14
    v_and_b32 v14, 6, v14
    v_xor_b32 v14, v14, v1
    v_and_b32 v14, 7, v14
    v_lshl_add_u32 v60, v14, 4, v60
    s_lshl_b32 s65, s27, 7
    s_add_u32 s84, s84, s65
    v_mov_b32 v12, 0
    s_mov_b32 s68, 262144
L_wpl:
    ds_read_b128 v[8:11], v12 offset:10112
    s_waitcnt lgkmcnt(0)
    v_min3_u32 v8, v8, v9, v10
    v_min_u32 v8, v8, v11
    v_cmp_gt_u32 vcc, 29, v8
    s_cbranch_vccz L_wql
    s_sleep 32
    s_sub_u32 s68, s68, 1
    s_cmp_lg_u32 s68, 0
    s_cbranch_scc1 L_wpl
L_wql:
    v_mov_b32 v12, 0
    s_mov_b32 s68, 4194304
L_wpm:
    ds_read_b128 v[8:11], v12 offset:10112
    s_waitcnt lgkmcnt(0)
    v_min3_u32 v8, v8, v9, v10
    v_min_u32 v8, v8, v11
    v_cmp_gt_u32 vcc, 31, v8
    s_cbranch_vccz L_wqm
    s_sleep 1
    s_sub_u32 s68, s68, 1
    s_cmp_lg_u32 s68, 0
    s_cbranch_scc1 L_wpm
L_wqm:
    s_mov_b32 m0, 47104
    s_nop 0
    buffer_load_dwordx4 v60, s[76:79], s84 offen nt lds
    s_add_u32 s84, s84, 10240
    s_mov_b32 m0, 48128
    s_nop 0
    buffer_load_dwordx4 v60, s[76:79], s84 offen nt lds
    s_add_u32 s84, s84, 10240
    s_mov_b32 m0, 49152
    s_nop 0
    buffer_load_dwordx4 v60, s[76:79], s84 offen nt lds
    s_add_u32 s84, s84, 10240
    s_mov_b32 m0, 50176
    s_nop 0
    buffer_load_dwordx4 v60, s[76:79], s84 offen nt lds
    s_add_u32 s84, s84, 10240
    s_mov_b32 m0, 51200
    s_nop 0
    buffer_load_dwordx4 v60, s[76:79], s84 offen nt lds
    s_add_u32 s84, s84, 10240
    s_mov_b32 m0, 52224
    s_nop 0
    buffer_load_dwordx4 v60, s[76:79], s84 offen nt lds
    s_add_u32 s84, s84, 10240
    s_mov_b32 m0, 53248
    s_nop 0
    buffer_load_dwordx4 v60, s[76:79], s84 offen nt lds
    s_add_u32 s84, s84, 10240
    s_mov_b32 m0, 54272
    s_nop 0
    buffer_load_dwordx4 v60, s[76:79], s84 offen nt lds
    s_add_u32 s84, s84, 10240
    s_mov_b32 m0, 55296
    s_nop 0
    buffer_load_dwordx4 v60, s[76:79], s84 offen nt lds
    s_add_u32 s84, s84, 10240
    s_mov_b32 m0, 56320
    s_nop 0
    buffer_load_dwordx4 v60, s[76:79], s84 offen nt lds
    s_add_u32 s84, s84, 10240
    s_mov_b32 m0, 57344
    s_nop 0
    buffer_load_dwordx4 v60, s[76:79], s84 offen nt lds
    s_add_u32 s84, s84, 10240
    s_mov_b32 m0, 58368
    s_nop 0
    buffer_load_dwordx4 v60, s[76:79], s84 offen nt lds
    s_add_u32 s84, s84, 10240
    s_mov_b32 m0, 59392
    s_nop 0
    buffer_load_dwordx4 v60, s[76:79], s84 offen nt lds
    s_add_u32 s84, s84, 10240
    s_mov_b32 m0, 60416
    s_nop 0
    buffer_load_dwordx4 v60, s[76:79], s84 offen nt lds
    s_add_u32 s84, s84, 10240
    s_mov_b32 m0, 61440
    s_nop 0
    buffer_load_dwordx4 v60, s[76:79], s84 offen nt lds
    s_add_u32 s84, s84, 10240
    s_mov_b32 m0, 62464
    s_nop 0
    buffer_load_dwordx4 v60, s[76:79], s84 offen nt lds
    s_add_u32 s84, s84, 10240
    s_mov_b32 m0, 63488
    s_nop 0
    buffer_load_dwordx4 v60, s[76:79], s84 offen nt lds
    s_add_u32 s84, s84, 10240
    s_mov_b32 m0, 64512
    s_nop 0
    buffer_load_dwordx4 v60, s[76:79], s84 offen nt lds
    s_add_u32 s84, s84, 10240
    s_mov_b32 m0, 65536
    s_nop 0
    buffer_load_dwordx4 v60, s[76:79], s84 offen nt lds
    s_add_u32 s84, s84, 10240
    s_mov_b32 m0, 66560
    s_nop 0
    buffer_load_dwordx4 v60, s[76:79], s84 offen nt lds
    s_add_u32 s84, s84, 10240
    s_mov_b32 m0, 67584
    s_nop 0
    buffer_load_dwordx4 v60, s[76:79], s84 offen nt lds
    s_add_u32 s84, s84, 10240
    s_mov_b32 m0, 68608
    s_nop 0
    buffer_load_dwordx4 v60, s[76:79], s84 offen nt lds
    s_add_u32 s84, s84, 10240
    s_mov_b32 m0, 69632
    s_nop 0
    buffer_load_dwordx4 v60, s[76:79], s84 offen nt lds
    s_add_u32 s84, s84, 10240
    s_mov_b32 m0, 70656
    s_nop 0
    buffer_load_dwordx4 v60, s[76:79], s84 offen nt lds
    s_add_u32 s84, s84, 10240
    s_barrier
    s_mov_b32 s28, 4
L_owner:
    v_and_b32 v14, 15, v1
    v_lshrrev_b32 v15, 4, v1
    v_lshrrev_b32 v12, 2, v1
    v_and_b32 v13, 3, v1
    s_cmp_eq_u32 s28, 4
    s_cbranch_scc1 L_own4
    v_bfe_u32 v10, v1, 3, 2
    v_xor_b32 v10, s28, v10
    v_lshl_add_u32 v12, v12, 2, v10
    s_mov_b32 s65, 47104
    s_movk_i32 s66, 2048
    s_lshl_b32 s67, s27, 2
    s_add_u32 s67, s67, s28
    s_branch L_own5
L_own4:
    s_mov_b32 s65, 79872
    s_movk_i32 s66, 512
    s_add_u32 s67, s27, 32
L_own5:
    v_lshlrev_b32 v12, 5, v12
    v_lshl_add_u32 v12, v13, 3, v12
    v_add_u32 v48, s65, v12
    v_mul_u32_u24 v13, 544, v13
    v_lshl_add_u32 v13, v15, 4, v13
    v_add_u32 v49, s66, v48
    v_add_u32 v50, s66, v49
    v_add_u32 v51, s66, v50
    v_add_u32 v52, s66, v51
    v_add_u32 v53, s66, v52
    v_add_u32 v54, s66, v53
    v_add_u32 v55, s66, v54
    v_add_u32 v56, s66, v55
    v_add_u32 v57, s66, v56
    v_add_u32 v58, s66, v57
    v_add_u32 v59, s66, v58
    v_add_u32 v60, s66, v59
    v_add_u32 v61, s66, v60
    v_add_u32 v62, s66, v61
    v_add_u32 v63, s66, v62
    v_lshlrev_b32 v14, 4, v14
    v_mov_b32 v3, 0xffffff00
    s_mul_i32 s65, s26, 10240
    s_lshl_b32 s66, s67, 8
    s_add_u32 s65, s65, s66
    s_add_u32 s65, s65, 1179648
    s_waitcnt vmcnt(0)
    s_barrier
    ds_read_b128 v[40:43], v13 offset:1920
    ds_read_b128 v[44:47], v13 offset:1984
    ds_read_b64_tr_b16 v[108:109], v60
    ds_read_b64_tr_b16 v[110:111], v61
    ds_read_b64_tr_b16 v[112:113], v62
    ds_read_b64_tr_b16 v[114:115], v63
    ds_read_b64_tr_b16 v[84:85], v48
    ds_read_b64_tr_b16 v[86:87], v49
    ds_read_b64_tr_b16 v[88:89], v50
    ds_read_b64_tr_b16 v[90:91], v51
    s_waitcnt lgkmcnt(4)
    ds_read_b64_tr_b16 v[92:93], v52
    ds_read_b64_tr_b16 v[94:95], v53
    ds_read_b64_tr_b16 v[96:97], v54
    ds_read_b64_tr_b16 v[98:99], v55
    ds_read_b64_tr_b16 v[100:101], v56
    ds_read_b64_tr_b16 v[102:103], v57
    ds_read_b64_tr_b16 v[104:105], v58
    ds_read_b64_tr_b16 v[106:107], v59
    v_mfma_f32_16x16x32_bf16 v[8:11], v[40:43], v[108:111], 0
    v_mfma_f32_16x16x32_bf16 v[8:11], v[44:47], v[112:115], v[8:11]
    s_waitcnt lgkmcnt(0)
    s_barrier
    ds_read_b128 v[16:19], v13 offset:1536
    ds_read_b128 v[20:23], v13 offset:1600
    ds_read_b128 v[24:27], v13 offset:1664
    ds_read_b128 v[28:31], v13 offset:1728
    ds_read_b128 v[32:35], v13 offset:1792
    ds_read_b128 v[36:39], v13 offset:1856
    s_waitcnt lgkmcnt(5)
    v_mfma_f32_16x16x32_bf16 v[8:11], v[16:19], v[84:87], v[8:11]
    s_waitcnt lgkmcnt(4)
    v_mfma_f32_16x16x32_bf16 v[8:11], v[20:23], v[88:91], v[8:11]
    s_waitcnt lgkmcnt(3)
    v_mfma_f32_16x16x32_bf16 v[8:11], v[24:27], v[92:95], v[8:11]
    s_waitcnt lgkmcnt(2)
    v_mfma_f32_16x16x32_bf16 v[8:11], v[28:31], v[96:99], v[8:11]
    s_waitcnt lgkmcnt(1)
    v_mfma_f32_16x16x32_bf16 v[8:11], v[32:35], v[100:103], v[8:11]
    s_waitcnt lgkmcnt(0)
    v_mfma_f32_16x16x32_bf16 v[8:11], v[36:39], v[104:107], v[8:11]
    s_nop 7
    v_and_or_b32 v8, v8, v3, s57
    v_and_or_b32 v9, v9, v3, s58
    v_and_or_b32 v10, v10, v3, s59
    v_and_or_b32 v11, v11, v3, s60
    s_mov_b64 exec, 0xffff
    buffer_store_dwordx4 v[8:11], v14, s[48:51], s65 offen sc1
    s_mov_b64 exec, -1
    s_branch L_done
L_gath:
    v_bfe_u32 v12, v1, 4, 1
    v_lshrrev_b32 v13, 5, v1
    v_lshl_add_u32 v75, v12, 1, v13
    v_mul_u32_u24 v79, 10240, v82
    v_lshl_add_u32 v79, v83, 4, v79
    v_mul_u32_u24 v12, 1280, v75
    v_lshl_add_u32 v80, v83, 1, v12
    s_lshl_b32 s78, s2, 4
    s_cmp_lg_u32 s28, 0
    s_cbranch_scc1 L_noml
    buffer_load_ushort v74, v80, s[32:35], s78 offen
    v_mov_b32 v12, 0
    s_mov_b32 s68, 262144
L_wpk:
    ds_read_b128 v[8:11], v12 offset:10112
    s_waitcnt lgkmcnt(0)
    v_min3_u32 v8, v8, v9, v10
    v_min_u32 v8, v8, v11
    v_cmp_gt_u32 vcc, 16, v8
    s_cbranch_vccz L_wqk
    s_sleep 32
    s_sub_u32 s68, s68, 1
    s_cmp_lg_u32 s68, 0
    s_cbranch_scc1 L_wpk
L_wqk:
    v_lshrrev_b32 v14, 4, v1
    v_bfe_u32 v15, v1, 2, 2
    v_lshl_add_u32 v15, v15, 2, v14
    v_and_b32 v12, 3, v1
    v_lshl_add_u32 v15, v15, 2, v12
    v_lshlrev_b32 v15, 7, v15
    v_lshlrev_b32 v13, 4, v82
    v_lshlrev_b32 v14, 4, v14
    ds_read_b128 v[8:11], v14 offset:9984
    ds_read_b128 v[84:87], v15 offset:14336
    ds_read_b128 v[88:91], v15 offset:14352
    ds_read_b128 v[92:95], v15 offset:14368
    ds_read_b128 v[96:99], v15 offset:14384
    ds_read_b128 v[100:103], v15 offset:14400
    ds_read_b128 v[104:107], v15 offset:14416
    ds_read_b128 v[108:111], v15 offset:14432
    ds_read_b128 v[112:115], v15 offset:14448
    s_waitcnt vmcnt(0) lgkmcnt(0)
    v_lshlrev_b32 v74, 16, v74
    v_max3_f32 v8, v8, v9, v10
    v_max_f32 v8, v8, v11
    v_mov_b32 v9, 0
    v_lshlrev_b32 v16, 16, v84
    v_and_b32 v17, v81, v84
    v_lshlrev_b32 v18, 16, v85
    v_and_b32 v19, v81, v85
    v_sub_f32 v16, v16, v8
    v_sub_f32 v17, v17, v8
    v_sub_f32 v18, v18, v8
    v_sub_f32 v19, v19, v8
    v_mul_f32 v16, s72, v16
    v_mul_f32 v17, s72, v17
    v_mul_f32 v18, s72, v18
    v_mul_f32 v19, s72, v19
    v_exp_f32 v16, v16
    v_exp_f32 v17, v17
    v_exp_f32 v18, v18
    v_exp_f32 v19, v19
    v_add_f32 v16, v16, v17
    v_add_f32 v18, v18, v19
    v_add_f32 v16, v16, v18
    v_add_f32 v9, v9, v16
    v_lshlrev_b32 v16, 16, v86
    v_and_b32 v17, v81, v86
    v_lshlrev_b32 v18, 16, v87
    v_and_b32 v19, v81, v87
    v_sub_f32 v16, v16, v8
    v_sub_f32 v17, v17, v8
    v_sub_f32 v18, v18, v8
    v_sub_f32 v19, v19, v8
    v_mul_f32 v16, s72, v16
    v_mul_f32 v17, s72, v17
    v_mul_f32 v18, s72, v18
    v_mul_f32 v19, s72, v19
    v_exp_f32 v16, v16
    v_exp_f32 v17, v17
    v_exp_f32 v18, v18
    v_exp_f32 v19, v19
    v_add_f32 v16, v16, v17
    v_add_f32 v18, v18, v19
    v_add_f32 v16, v16, v18
    v_add_f32 v9, v9, v16
    v_lshlrev_b32 v16, 16, v88
    v_and_b32 v17, v81, v88
    v_lshlrev_b32 v18, 16, v89
    v_and_b32 v19, v81, v89
    v_sub_f32 v16, v16, v8
    v_sub_f32 v17, v17, v8
    v_sub_f32 v18, v18, v8
    v_sub_f32 v19, v19, v8
    v_mul_f32 v16, s72, v16
    v_mul_f32 v17, s72, v17
    v_mul_f32 v18, s72, v18
    v_mul_f32 v19, s72, v19
    v_exp_f32 v16, v16
    v_exp_f32 v17, v17
    v_exp_f32 v18, v18
    v_exp_f32 v19, v19
    v_add_f32 v16, v16, v17
    v_add_f32 v18, v18, v19
    v_add_f32 v16, v16, v18
    v_add_f32 v9, v9, v16
    v_lshlrev_b32 v16, 16, v90
    v_and_b32 v17, v81, v90
    v_lshlrev_b32 v18, 16, v91
    v_and_b32 v19, v81, v91
    v_sub_f32 v16, v16, v8
    v_sub_f32 v17, v17, v8
    v_sub_f32 v18, v18, v8
    v_sub_f32 v19, v19, v8
    v_mul_f32 v16, s72, v16
    v_mul_f32 v17, s72, v17
    v_mul_f32 v18, s72, v18
    v_mul_f32 v19, s72, v19
    v_exp_f32 v16, v16
    v_exp_f32 v17, v17
    v_exp_f32 v18, v18
    v_exp_f32 v19, v19
    v_add_f32 v16, v16, v17
    v_add_f32 v18, v18, v19
    v_add_f32 v16, v16, v18
    v_add_f32 v9, v9, v16
    v_lshlrev_b32 v16, 16, v92
    v_and_b32 v17, v81, v92
    v_lshlrev_b32 v18, 16, v93
    v_and_b32 v19, v81, v93
    v_sub_f32 v16, v16, v8
    v_sub_f32 v17, v17, v8
    v_sub_f32 v18, v18, v8
    v_sub_f32 v19, v19, v8
    v_mul_f32 v16, s72, v16
    v_mul_f32 v17, s72, v17
    v_mul_f32 v18, s72, v18
    v_mul_f32 v19, s72, v19
    v_exp_f32 v16, v16
    v_exp_f32 v17, v17
    v_exp_f32 v18, v18
    v_exp_f32 v19, v19
    v_add_f32 v16, v16, v17
    v_add_f32 v18, v18, v19
    v_add_f32 v16, v16, v18
    v_add_f32 v9, v9, v16
    v_lshlrev_b32 v16, 16, v94
    v_and_b32 v17, v81, v94
    v_lshlrev_b32 v18, 16, v95
    v_and_b32 v19, v81, v95
    v_sub_f32 v16, v16, v8
    v_sub_f32 v17, v17, v8
    v_sub_f32 v18, v18, v8
    v_sub_f32 v19, v19, v8
    v_mul_f32 v16, s72, v16
    v_mul_f32 v17, s72, v17
    v_mul_f32 v18, s72, v18
    v_mul_f32 v19, s72, v19
    v_exp_f32 v16, v16
    v_exp_f32 v17, v17
    v_exp_f32 v18, v18
    v_exp_f32 v19, v19
    v_add_f32 v16, v16, v17
    v_add_f32 v18, v18, v19
    v_add_f32 v16, v16, v18
    v_add_f32 v9, v9, v16
    v_lshlrev_b32 v16, 16, v96
    v_and_b32 v17, v81, v96
    v_lshlrev_b32 v18, 16, v97
    v_and_b32 v19, v81, v97
    v_sub_f32 v16, v16, v8
    v_sub_f32 v17, v17, v8
    v_sub_f32 v18, v18, v8
    v_sub_f32 v19, v19, v8
    v_mul_f32 v16, s72, v16
    v_mul_f32 v17, s72, v17
    v_mul_f32 v18, s72, v18
    v_mul_f32 v19, s72, v19
    v_exp_f32 v16, v16
    v_exp_f32 v17, v17
    v_exp_f32 v18, v18
    v_exp_f32 v19, v19
    v_add_f32 v16, v16, v17
    v_add_f32 v18, v18, v19
    v_add_f32 v16, v16, v18
    v_add_f32 v9, v9, v16
    v_lshlrev_b32 v16, 16, v98
    v_and_b32 v17, v81, v98
    v_lshlrev_b32 v18, 16, v99
    v_and_b32 v19, v81, v99
    v_sub_f32 v16, v16, v8
    v_sub_f32 v17, v17, v8
    v_sub_f32 v18, v18, v8
    v_sub_f32 v19, v19, v8
    v_mul_f32 v16, s72, v16
    v_mul_f32 v17, s72, v17
    v_mul_f32 v18, s72, v18
    v_mul_f32 v19, s72, v19
    v_exp_f32 v16, v16
    v_exp_f32 v17, v17
    v_exp_f32 v18, v18
    v_exp_f32 v19, v19
    v_add_f32 v16, v16, v17
    v_add_f32 v18, v18, v19
    v_add_f32 v16, v16, v18
    v_add_f32 v9, v9, v16
    v_lshlrev_b32 v16, 16, v100
    v_and_b32 v17, v81, v100
    v_lshlrev_b32 v18, 16, v101
    v_and_b32 v19, v81, v101
    v_sub_f32 v16, v16, v8
    v_sub_f32 v17, v17, v8
    v_sub_f32 v18, v18, v8
    v_sub_f32 v19, v19, v8
    v_mul_f32 v16, s72, v16
    v_mul_f32 v17, s72, v17
    v_mul_f32 v18, s72, v18
    v_mul_f32 v19, s72, v19
    v_exp_f32 v16, v16
    v_exp_f32 v17, v17
    v_exp_f32 v18, v18
    v_exp_f32 v19, v19
    v_add_f32 v16, v16, v17
    v_add_f32 v18, v18, v19
    v_add_f32 v16, v16, v18
    v_add_f32 v9, v9, v16
    v_lshlrev_b32 v16, 16, v102
    v_and_b32 v17, v81, v102
    v_lshlrev_b32 v18, 16, v103
    v_and_b32 v19, v81, v103
    v_sub_f32 v16, v16, v8
    v_sub_f32 v17, v17, v8
    v_sub_f32 v18, v18, v8
    v_sub_f32 v19, v19, v8
    v_mul_f32 v16, s72, v16
    v_mul_f32 v17, s72, v17
    v_mul_f32 v18, s72, v18
    v_mul_f32 v19, s72, v19
    v_exp_f32 v16, v16
    v_exp_f32 v17, v17
    v_exp_f32 v18, v18
    v_exp_f32 v19, v19
    v_add_f32 v16, v16, v17
    v_add_f32 v18, v18, v19
    v_add_f32 v16, v16, v18
    v_add_f32 v9, v9, v16
    v_lshlrev_b32 v16, 16, v104
    v_and_b32 v17, v81, v104
    v_lshlrev_b32 v18, 16, v105
    v_and_b32 v19, v81, v105
    v_sub_f32 v16, v16, v8
    v_sub_f32 v17, v17, v8
    v_sub_f32 v18, v18, v8
    v_sub_f32 v19, v19, v8
    v_mul_f32 v16, s72, v16
    v_mul_f32 v17, s72, v17
    v_mul_f32 v18, s72, v18
    v_mul_f32 v19, s72, v19
    v_exp_f32 v16, v16
    v_exp_f32 v17, v17
    v_exp_f32 v18, v18
    v_exp_f32 v19, v19
    v_add_f32 v16, v16, v17
    v_add_f32 v18, v18, v19
    v_add_f32 v16, v16, v18
    v_add_f32 v9, v9, v16
    v_lshlrev_b32 v16, 16, v106
    v_and_b32 v17, v81, v106
    v_lshlrev_b32 v18, 16, v107
    v_and_b32 v19, v81, v107
    v_sub_f32 v16, v16, v8
    v_sub_f32 v17, v17, v8
    v_sub_f32 v18, v18, v8
    v_sub_f32 v19, v19, v8
    v_mul_f32 v16, s72, v16
    v_mul_f32 v17, s72, v17
    v_mul_f32 v18, s72, v18
    v_mul_f32 v19, s72, v19
    v_exp_f32 v16, v16
    v_exp_f32 v17, v17
    v_exp_f32 v18, v18
    v_exp_f32 v19, v19
    v_add_f32 v16, v16, v17
    v_add_f32 v18, v18, v19
    v_add_f32 v16, v16, v18
    v_add_f32 v9, v9, v16
    v_lshlrev_b32 v16, 16, v108
    v_and_b32 v17, v81, v108
    v_lshlrev_b32 v18, 16, v109
    v_and_b32 v19, v81, v109
    v_sub_f32 v16, v16, v8
    v_sub_f32 v17, v17, v8
    v_sub_f32 v18, v18, v8
    v_sub_f32 v19, v19, v8
    v_mul_f32 v16, s72, v16
    v_mul_f32 v17, s72, v17
    v_mul_f32 v18, s72, v18
    v_mul_f32 v19, s72, v19
    v_exp_f32 v16, v16
    v_exp_f32 v17, v17
    v_exp_f32 v18, v18
    v_exp_f32 v19, v19
    v_add_f32 v16, v16, v17
    v_add_f32 v18, v18, v19
    v_add_f32 v16, v16, v18
    v_add_f32 v9, v9, v16
    v_lshlrev_b32 v16, 16, v110
    v_and_b32 v17, v81, v110
    v_lshlrev_b32 v18, 16, v111
    v_and_b32 v19, v81, v111
    v_sub_f32 v16, v16, v8
    v_sub_f32 v17, v17, v8
    v_sub_f32 v18, v18, v8
    v_sub_f32 v19, v19, v8
    v_mul_f32 v16, s72, v16
    v_mul_f32 v17, s72, v17
    v_mul_f32 v18, s72, v18
    v_mul_f32 v19, s72, v19
    v_exp_f32 v16, v16
    v_exp_f32 v17, v17
    v_exp_f32 v18, v18
    v_exp_f32 v19, v19
    v_add_f32 v16, v16, v17
    v_add_f32 v18, v18, v19
    v_add_f32 v16, v16, v18
    v_add_f32 v9, v9, v16
    v_lshlrev_b32 v16, 16, v112
    v_and_b32 v17, v81, v112
    v_lshlrev_b32 v18, 16, v113
    v_and_b32 v19, v81, v113
    v_sub_f32 v16, v16, v8
    v_sub_f32 v17, v17, v8
    v_sub_f32 v18, v18, v8
    v_sub_f32 v19, v19, v8
    v_mul_f32 v16, s72, v16
    v_mul_f32 v17, s72, v17
    v_mul_f32 v18, s72, v18
    v_mul_f32 v19, s72, v19
    v_exp_f32 v16, v16
    v_exp_f32 v17, v17
    v_exp_f32 v18, v18
    v_exp_f32 v19, v19
    v_add_f32 v16, v16, v17
    v_add_f32 v18, v18, v19
    v_add_f32 v16, v16, v18
    v_add_f32 v9, v9, v16
    v_lshlrev_b32 v16, 16, v114
    v_and_b32 v17, v81, v114
    v_lshlrev_b32 v18, 16, v115
    v_and_b32 v19, v81, v115
    v_sub_f32 v16, v16, v8
    v_sub_f32 v17, v17, v8
    v_sub_f32 v18, v18, v8
    v_sub_f32 v19, v19, v8
    v_mul_f32 v16, s72, v16
    v_mul_f32 v17, s72, v17
    v_mul_f32 v18, s72, v18
    v_mul_f32 v19, s72, v19
    v_exp_f32 v16, v16
    v_exp_f32 v17, v17
    v_exp_f32 v18, v18
    v_exp_f32 v19, v19
    v_add_f32 v16, v16, v17
    v_add_f32 v18, v18, v19
    v_add_f32 v16, v16, v18
    v_add_f32 v9, v9, v16
    s_nop 1
    v_add_f32_dpp v9, v9, v9 row_ror:8 row_mask:0xf bank_mask:0xf
    s_nop 1
    v_add_f32_dpp v9, v9, v9 row_ror:4 row_mask:0xf bank_mask:0xf
    s_nop 1
    v_add_f32_dpp v9, v9, v9 row_ror:2 row_mask:0xf bank_mask:0xf
    s_nop 1
    v_add_f32_dpp v9, v9, v9 row_ror:1 row_mask:0xf bank_mask:0xf
    s_lshl_b32 s65, s74, 8
    v_mov_b32 v10, s65
    v_and_or_b32 v8, v8, v3, s57
    v_and_or_b32 v9, v9, v3, s58
    v_and_or_b32 v10, v10, v3, s59
    v_and_or_b32 v11, v11, v3, s60
    s_lshl_b32 s65, s26, 3
    s_add_u32 s65, s65, s27
    s_lshl_b32 s65, s65, 7
    s_add_u32 s65, s65, 327680
    s_mov_b32 s80, 0x01010101
    s_mov_b32 s81, 0x01010101
    s_mov_b64 exec, s[80:81]
    buffer_store_dwordx4 v[8:11], v13, s[48:51], s65 offen sc1
    s_mov_b64 exec, -1
L_noml:
    v_mov_b32 v12, 0
    s_mov_b32 s68, 262144
L_wpv:
    ds_read_b128 v[8:11], v12 offset:10112
    s_waitcnt lgkmcnt(0)
    v_min3_u32 v8, v8, v9, v10
    v_min_u32 v8, v8, v11
    v_cmp_gt_u32 vcc, 18, v8
    s_cbranch_vccz L_wqv
    s_sleep 32
    s_sub_u32 s68, s68, 1
    s_cmp_lg_u32 s68, 0
    s_cbranch_scc1 L_wpv
L_wqv:
    v_lshlrev_b32 v14, 4, v82
    v_lshl_add_u32 v14, v83, 7, v14
    v_lshrrev_b32 v13, 4, v1
    v_lshlrev_b32 v15, 2, v13
    ds_read_b32 v40, v15 offset:9984
    ds_read_b32 v41, v15 offset:10000
    ds_read_b32 v42, v15 offset:10016
    ds_read_b32 v43, v15 offset:10032
    v_and_b32 v12, 15, v1
    s_lshl_b32 s65, s28, 4
    v_add_u32 v15, s65, v12
    v_mul_u32_u24 v77, 1536, v13
    v_lshl_add_u32 v77, v15, 4, v77
    v_and_b32 v73, 3, v15
    v_bfe_u32 v78, v15, 2, 1
    v_lshl_add_u32 v73, v73, 1, v78
    v_and_b32 v78, 0x38, v15
    v_or_b32 v78, v78, v73
    v_lshl_add_u32 v15, v78, 2, v75
    v_lshlrev_b32 v78, 1, v15
    v_lshl_add_u32 v12, v12, 2, v75
    v_lshlrev_b32 v73, 2, v12
    v_lshlrev_b32 v71, 3, v75
    s_lshl_b32 s73, s26, 10
    s_add_u32 s73, s73, 327680
    s_mov_b32 s68, 262144
L_pollm:
    buffer_load_dwordx4 v[16:19], v14, s[48:51], s73 offen sc1
    s_waitcnt vmcnt(0)
    v_xor_b32 v16, s57, v16
    v_xor_b32 v17, s58, v17
    v_xor_b32 v18, s59, v18
    v_xor_b32 v19, s60, v19
    v_or3_b32 v12, v16, v17, v18
    v_or_b32 v12, v12, v19
    v_and_b32 v12, 0xff, v12
    v_cmp_ne_u32 vcc, 0, v12
    s_cbranch_vccz L_gotm
    s_sleep 8
    s_sub_u32 s68, s68, 1
    s_cmp_lg_u32 s68, 0
    s_cbranch_scc1 L_pollm
L_gotm:
    v_readfirstlane_b32 s65, v18
    s_nop 1
    v_cmp_ne_u32 vcc, s65, v18
    s_or_b32 s88, vcc_lo, vcc_hi
    s_cselect_b32 s65, 393216, 0
    s_mul_i32 s74, s26, 3
    s_add_u32 s74, s74, s28
    s_lshl_b32 s74, s74, 12
    s_add_u32 s74, s74, s65
    s_add_u32 s74, s74, 393216
    s_lshl_b32 s76, s27, 8
    s_add_u32 s76, s76, s74
    v_max_f32_dpp v32, v16, v16 quad_perm:[1,0,3,2] row_mask:0xf bank_mask:0xf
    s_nop 1
    v_max_f32_dpp v32, v32, v32 quad_perm:[2,3,0,1] row_mask:0xf bank_mask:0xf
    s_nop 1
    v_max_f32_dpp v32, v32, v32 row_half_mirror row_mask:0xf bank_mask:0xf
    v_sub_f32 v16, v16, v32
    v_mul_f32 v16, s72, v16
    v_exp_f32 v16, v16
    s_nop 0
    v_mul_f32 v33, v16, v17
    s_nop 1
    v_add_f32_dpp v33, v33, v33 quad_perm:[1,0,3,2] row_mask:0xf bank_mask:0xf
    s_nop 1
    v_add_f32_dpp v33, v33, v33 quad_perm:[2,3,0,1] row_mask:0xf bank_mask:0xf
    s_nop 1
    v_add_f32_dpp v33, v33, v33 row_half_mirror row_mask:0xf bank_mask:0xf
    v_rcp_f32 v33, v33
    s_waitcnt lgkmcnt(0)
    v_readlane_b32 s65, v32, 0
    v_readlane_b32 s66, v33, 0
    s_nop 0
    v_subrev_f32 v40, s65, v40
    v_mul_f32 v40, s72, v40
    v_exp_f32 v40, v40
    s_nop 0
    v_mul_f32 v40, s66, v40
    v_readlane_b32 s65, v32, 16
    v_readlane_b32 s66, v33, 16
    s_nop 0
    v_subrev_f32 v41, s65, v41
    v_mul_f32 v41, s72, v41
    v_exp_f32 v41, v41
    s_nop 0
    v_mul_f32 v41, s66, v41
    v_readlane_b32 s65, v32, 32
    v_readlane_b32 s66, v33, 32
    s_nop 0
    v_subrev_f32 v42, s65, v42
    v_mul_f32 v42, s72, v42
    v_exp_f32 v42, v42
    s_nop 0
    v_mul_f32 v42, s66, v42
    v_readlane_b32 s65, v32, 48
    v_readlane_b32 s66, v33, 48
    s_nop 0
    v_subrev_f32 v43, s65, v43
    v_mul_f32 v43, s72, v43
    v_exp_f32 v43, v43
    s_nop 0
    v_mul_f32 v43, s66, v43
    s_mov_b32 s84, s56
    s_mov_b32 s79, 20
L_hb0:
    s_add_u32 s84, s84, 0x11111111
    v_bfe_u32 v72, s84, v71, 8
    s_bfe_u32 s80, s84, 524288
    s_bfe_u32 s81, s84, 524296
    s_bfe_u32 s82, s84, 524304
    s_bfe_u32 s83, s84, 524312
L_hb:
    s_cmp_eq_u32 s79, 32
    s_cbranch_scc1 L_hb1
    v_mov_b32 v12, 0
    s_mov_b32 s68, 262144
L_wpb:
    ds_read_b128 v[8:11], v12 offset:10112
    s_waitcnt lgkmcnt(0)
    v_min3_u32 v8, v8, v9, v10
    v_min_u32 v8, v8, v11
    v_cmp_gt_u32 vcc, s79, v8
    s_cbranch_vccz L_wqb
    s_sleep 16
    s_sub_u32 s68, s68, 1
    s_cmp_lg_u32 s68, 0
    s_cbranch_scc1 L_wpb
L_wqb:
    s_branch L_hb2
L_hb1:
    s_barrier
L_hb2:
    ds_read_b128 v[8:11], v77 offset:22528
    ds_read_b128 v[12:15], v77 offset:23296
    s_mov_b32 s68, 262144
    s_cmp_lg_u32 s88, 0
    s_waitcnt lgkmcnt(0)
    v_add_f32 v8, v8, v12
    v_add_f32 v9, v9, v13
    v_add_f32 v10, v10, v14
    v_add_f32 v11, v11, v15
    v_mul_f32 v8, v8, v40
    v_mul_f32 v9, v9, v40
    v_mul_f32 v10, v10, v40
    v_mul_f32 v11, v11, v40
    v_permlane32_swap_b32 v8, v9
    s_nop 0
    v_permlane32_swap_b32 v10, v11
    v_add_f32 v8, v8, v9
    v_add_f32 v10, v10, v11
    s_nop 1
    v_permlane16_swap_b32 v8, v10
    v_add_f32 v8, v8, v10
    v_and_or_b32 v8, v8, v3, v72
    s_cbranch_scc1 L_farst
    buffer_store_dword v8, v73, s[48:51], s76 offen
L_stored:
    s_cmp_lg_u32 s79, 32
    s_cbranch_scc1 L_pollp
    s_barrier
L_pollp:
    s_cmp_lg_u32 s88, 0
    s_cbranch_scc1 L_farld
    buffer_load_dwordx4 v[16:19], v76, s[48:51], s74 offen nt
    buffer_load_dwordx4 v[20:23], v76, s[48:51], s74 offen offset:1024 nt
L_chkp:
    s_waitcnt vmcnt(0)
    v_xor_b32 v16, s80, v16
    v_xor_b32 v17, s81, v17
    v_xor_b32 v18, s82, v18
    v_xor_b32 v19, s83, v19
    v_or3_b32 v12, v16, v17, v18
    v_or_b32 v12, v12, v19
    v_xor_b32 v20, s80, v20
    v_xor_b32 v21, s81, v21
    v_xor_b32 v22, s82, v22
    v_xor_b32 v23, s83, v23
    v_or3_b32 v12, v12, v20, v21
    v_or3_b32 v12, v12, v22, v23
    v_and_b32 v12, 0xff, v12
    v_cmp_ne_u32 vcc, 0, v12
    s_cbranch_vccz L_gotp
    s_sleep 1
    s_sub_u32 s68, s68, 1
    s_cmp_lg_u32 s68, 0
    s_cbranch_scc1 L_pollp
L_gotp:
    v_add_f32 v16, v16, v20
    v_add_f32 v17, v17, v21
    v_add_f32 v18, v18, v22
    v_add_f32 v19, v19, v23
    v_permlane32_swap_b32 v16, v17
    s_nop 0
    v_permlane32_swap_b32 v18, v19
    v_add_f32 v16, v16, v17
    v_add_f32 v18, v18, v19
    s_nop 1
    v_permlane16_swap_b32 v16, v18
    v_add_f32 v16, v16, v18
    v_cvt_pk_bf16_f32 v16, v16, v16
    ds_write_b16 v78, v16 offset:1536
    s_cmp_eq_u32 s79, 32
    s_cbranch_scc1 L_hb3
    v_add_u32 v77, 6144, v77
    v_add_u32 v78, 544, v78
    v_mov_b32 v40, v41
    v_mov_b32 v41, v42
    v_mov_b32 v42, v43
    s_xor_b32 s74, s74, 2048
    s_xor_b32 s76, s76, 2048
    s_add_u32 s79, s79, 4
    s_cmp_eq_u32 s79, 28
    s_cbranch_scc1 L_hb0
    s_branch L_hb
L_farst:
    buffer_store_dword v8, v73, s[48:51], s76 offen sc1
    s_waitcnt vmcnt(0)
    s_branch L_stored
L_farld:
    buffer_load_dwordx4 v[16:19], v76, s[48:51], s74 offen sc1
    buffer_load_dwordx4 v[20:23], v76, s[48:51], s74 offen offset:1024 sc1
    s_branch L_chkp
L_hb3:
    s_waitcnt lgkmcnt(0)
    s_barrier
    s_cmp_lg_u32 s28, 0
    s_cbranch_scc1 L_done
    s_cmp_ge_u32 s2, 80
    s_cbranch_scc1 L_done
    s_mov_b32 s68, 262144
    s_lshl_b32 s77, s2, 7
    s_add_u32 s77, s77, 1179648
    s_add_u32 s65, s77, 81920
    s_add_u32 s66, s77, 163840
    s_add_u32 s67, s77, 245760
    s_mov_b32 s52, s20
    s_mov_b32 s53, s21
    s_mov_b32 s54, 5120
    s_mov_b32 s55, 0x20000
    s_mov_b32 s80, 0x00ff00ff
    s_mov_b32 s81, 0x00ff00ff
L_polly:
    buffer_load_dwordx4 v[16:19], v79, s[48:51], s77 offen sc1
    buffer_load_dwordx4 v[20:23], v79, s[48:51], s65 offen sc1
    buffer_load_dwordx4 v[24:27], v79, s[48:51], s66 offen sc1
    buffer_load_dwordx4 v[28:31], v79, s[48:51], s67 offen sc1
    s_waitcnt vmcnt(3)
    v_xor_b32 v16, s57, v16
    v_xor_b32 v17, s58, v17
    v_xor_b32 v18, s59, v18
    v_xor_b32 v19, s60, v19
    v_or3_b32 v12, v16, v17, v18
    v_or_b32 v12, v12, v19
    s_waitcnt vmcnt(2)
    v_xor_b32 v20, s57, v20
    v_xor_b32 v21, s58, v21
    v_xor_b32 v22, s59, v22
    v_xor_b32 v23, s60, v23
    v_or3_b32 v12, v12, v20, v21
    v_or3_b32 v12, v12, v22, v23
    s_waitcnt vmcnt(1)
    v_xor_b32 v24, s57, v24
    v_xor_b32 v25, s58, v25
    v_xor_b32 v26, s59, v26
    v_xor_b32 v27, s60, v27
    v_or3_b32 v12, v12, v24, v25
    v_or3_b32 v12, v12, v26, v27
    s_waitcnt vmcnt(0)
    v_xor_b32 v28, s57, v28
    v_xor_b32 v29, s58, v29
    v_xor_b32 v30, s59, v30
    v_xor_b32 v31, s60, v31
    v_or3_b32 v12, v12, v28, v29
    v_or3_b32 v12, v12, v30, v31
    v_and_b32 v12, 0xff, v12
    v_cmp_ne_u32 vcc, 0, v12
    s_cbranch_vccz L_goty
    s_sleep 1
    s_sub_u32 s68, s68, 1
    s_cmp_lg_u32 s68, 0
    s_cbranch_scc1 L_polly
L_goty:
    v_add_f32 v16, v16, v24
    v_add_f32 v17, v17, v25
    v_add_f32 v18, v18, v26
    v_add_f32 v19, v19, v27
    v_add_f32 v20, v20, v28
    v_add_f32 v21, v21, v29
    v_add_f32 v22, v22, v30
    v_add_f32 v23, v23, v31
    v_add_f32 v16, v16, v20
    v_add_f32 v17, v17, v21
    v_add_f32 v18, v18, v22
    v_add_f32 v19, v19, v23
    v_permlane32_swap_b32 v16, v17
    s_nop 0
    v_permlane32_swap_b32 v18, v19
    v_add_f32 v16, v16, v17
    v_add_f32 v18, v18, v19
    s_nop 1
    v_permlane16_swap_b32 v16, v18
    v_add_f32 v16, v16, v18
    s_nop 1
    v_add_f32_dpp v16, v16, v16 row_ror:8 row_mask:0xf bank_mask:0xf
    v_add_f32 v16, v16, v74
    v_cvt_pk_bf16_f32 v16, v16, v16
    s_mov_b64 exec, s[80:81]
    buffer_store_short v16, v80, s[52:55], s78 offen
    s_mov_b64 exec, -1
    s_cmp_lg_u32 s2, 0
    s_cbranch_scc1 L_done
    v_mov_b32 v8, s84
    v_mov_b32 v9, 0
    s_mov_b64 exec, 1
    buffer_store_dword v8, v9, s[48:51], 0 offen
    s_mov_b64 exec, -1
    s_branch L_done
L_stream:
    v_bfe_u32 v14, v1, 1, 3
    v_mul_u32_u24 v14, 384, v14
    v_lshrrev_b32 v15, 4, v1
    v_and_b32 v16, 1, v1
    v_lshl_add_u32 v12, v15, 1, v16
    v_lshlrev_b32 v12, 4, v12
    v_add_u32 v2, v14, v12
    s_mul_i32 s39, s26, 3145728
    s_lshl_b32 s35, s27, 2
    s_add_u32 s35, s35, s3
    s_mul_i32 s35, s35, 3072
    s_mov_b32 s34, 0
    s_mov_b32 s36, s35
    s_sub_u32 s30, 402653184, s39
    s_mov_b32 s31, 0x20000
    s_waitcnt lgkmcnt(0)
    s_add_u32 s28, s6, s39
    s_addc_u32 s29, s7, 0
    s_add_u32 s32, s8, s39
    s_addc_u32 s33, s9, 0
    buffer_load_dwordx4 v[80:83], v2, s[28:31], s36 offen offset:0 nt
    buffer_load_dwordx4 v[84:87], v2, s[28:31], s36 offen offset:128 nt
    buffer_load_dwordx4 v[88:91], v2, s[28:31], s36 offen offset:256 nt
    s_add_u32 s34, s34, 98304
    s_add_u32 s35, s35, 39936
    s_sub_u32 s37, s35, 98304
    s_cselect_b32 s35, s35, s37
    s_add_u32 s36, s34, s35
    s_mov_b32 s76, s12
    s_mov_b32 s77, s13
    s_mov_b32 s78, 7864320
    s_mov_b32 s79, 0x20000
    s_mul_i32 s85, s26, 81920
    s_mul_i32 s84, s85, 3
    v_lshrrev_b32 v19, 3, v1
    v_mul_u32_u24 v18, 1280, v19
    v_and_b32 v19, 6, v19
    v_xor_b32 v19, v19, v1
    v_and_b32 v19, 7, v19
    v_lshl_add_u32 v18, v19, 4, v18
    s_mov_b32 s80, s18
    s_mov_b32 s81, s19
    s_cmp_lt_u32 s26, 24
    s_cselect_b32 s82, 1966080, 0
    s_mov_b32 s83, 0x20000
    v_lshrrev_b32 v19, 1, v1
    v_mul_u32_u24 v19, 1280, v19
    v_lshl_add_u32 v19, v16, 4, v19
    s_mul_i32 s65, s3, 81920
    s_add_u32 s65, s65, s84
    s_cmp_lt_u32 s3, 3
    s_cselect_b32 s76, s76, s80
    s_cselect_b32 s77, s77, s81
    s_cselect_b32 s78, s78, s82
    s_cselect_b32 s65, s65, s85
    s_lshl_b32 s66, s27, 5
    s_add_u32 s65, s65, s66
    s_add_u32 s65, s65, 1024
    s_add_u32 s66, s65, 40960
    s_lshl_b32 s67, s3, 11
    s_mul_i32 s68, s3, 20480
    s_lshl_b32 s69, s27, 7
    s_add_u32 s68, s68, s69
    s_add_u32 s68, s68, s85
    s_add_u32 s69, s68, 10240
    s_barrier
    s_add_u32 m0, s67, 79872
    s_nop 0
    buffer_load_dwordx4 v19, s[76:79], s65 offen lds
    s_add_u32 m0, s67, 80896
    s_nop 0
    buffer_load_dwordx4 v19, s[76:79], s66 offen lds
    s_add_u32 m0, s67, 71680
    s_nop 0
    buffer_load_dwordx4 v18, s[80:83], s68 offen nt lds
    s_add_u32 m0, s67, 72704
    s_nop 0
    buffer_load_dwordx4 v18, s[80:83], s69 offen nt lds
    buffer_load_dwordx4 v[92:95], v2, s[28:31], s36 offen offset:0 nt
    buffer_load_dwordx4 v[96:99], v2, s[28:31], s36 offen offset:128 nt
    buffer_load_dwordx4 v[100:103], v2, s[28:31], s36 offen offset:256 nt
    s_add_u32 s34, s34, 98304
    s_add_u32 s35, s35, 39936
    s_sub_u32 s37, s35, 98304
    s_cselect_b32 s35, s35, s37
    s_add_u32 s36, s34, s35
    buffer_load_dwordx4 v[104:107], v2, s[28:31], s36 offen offset:0 nt
    buffer_load_dwordx4 v[108:111], v2, s[28:31], s36 offen offset:128 nt
    buffer_load_dwordx4 v[112:115], v2, s[28:31], s36 offen offset:256 nt
    s_add_u32 s34, s34, 98304
    s_add_u32 s35, s35, 39936
    s_sub_u32 s37, s35, 98304
    s_cselect_b32 s35, s35, s37
    s_add_u32 s36, s34, s35
    v_and_b32 v14, 1, v1
    v_lshlrev_b32 v14, 4, v14
    v_mov_b32 v15, 0xffff
    v_lshlrev_b32 v14, v14, v15
    v_bfe_u32 v15, v1, 1, 2
    v_cmp_eq_u32 vcc, 0, v15
    s_nop 1
    v_cndmask_b32 v4, 0, v14, vcc
    v_cmp_eq_u32 vcc, 1, v15
    s_nop 1
    v_cndmask_b32 v5, 0, v14, vcc
    v_cmp_eq_u32 vcc, 2, v15
    s_nop 1
    v_cndmask_b32 v6, 0, v14, vcc
    v_cmp_eq_u32 vcc, 3, v15
    s_nop 1
    v_cndmask_b32 v7, 0, v14, vcc
    s_load_dword s56, s[24:25], 0
    v_lshrrev_b32 v14, 3, v1
    v_mul_u32_u24 v15, 384, v14
    v_and_b32 v16, 7, v1
    v_lshl_add_u32 v3, v16, 4, v15
    s_lshl_b32 s39, s3, 11
    s_add_u32 s39, s39, 14336
    v_lshl_add_u32 v30, v14, 3, s39
    v_mov_b32 v11, 0xffff0000
    v_mov_b32 v8, 0xff800000
    s_mov_b32 s40, 0x3d93cd3a
    s_mov_b32 s41, 0x3fb8aa3b
    s_mov_b32 s42, 0x00ff00ff
    s_mov_b32 s43, 0xff00ff00
    s_mov_b32 s46, 0x01010101
    s_mov_b32 s47, 0x01010101
    s_mov_b32 s38, 0
    s_mov_b32 s73, 0
    s_mov_b32 s75, 0
    s_movk_i32 s74, 0x200
    v_lshrrev_b32 v14, 5, v1
    v_mul_u32_u24 v14, 768, v14
    v_lshl_add_u32 v14, v16, 5, v14
    v_bfe_u32 v15, v1, 4, 1
    v_lshl_add_u32 v14, v15, 4, v14
    s_mul_i32 s39, s3, 1536
    s_add_u32 s39, s39, 22528
    v_add_u32 v13, s39, v14
    s_lshl_b32 s39, s3, 2
    v_mov_b32 v29, s39
    v_add_u32 v31, 9984, v29
    s_lshr_b32 s37, s2, 3
    s_lshl_b32 s37, s37, 4
    v_add_u32 v28, s37, v29
    v_lshlrev_b32 v15, 3, v1
    v_mov_b32 v48, 0
    v_mov_b32 v49, 0
    v_mov_b32 v50, 0
    v_mov_b32 v51, 0
    v_mov_b32 v52, 0
    v_mov_b32 v53, 0
    v_mov_b32 v54, 0
    v_mov_b32 v55, 0
    v_mov_b32 v56, 0
    v_mov_b32 v57, 0
    v_mov_b32 v58, 0
    v_mov_b32 v59, 0
    s_mov_b32 s48, s24
    s_mov_b32 s49, s25
    s_mov_b32 s50, 1769472
    s_mov_b32 s51, 0x20000
    ds_write_b32 v29, v48 offset:10112
    s_waitcnt lgkmcnt(0)
    s_add_u32 s56, s56, 0x11111111
    s_bfe_u32 s57, s56, 524288
    s_bfe_u32 s58, s56, 524296
    s_bfe_u32 s59, s56, 524304
    s_bfe_u32 s60, s56, 524312
    s_lshl_b32 s70, s56, 12
    s_and_b32 s71, s2, 7
    s_lshl_b32 s71, s71, 12
    s_add_u32 s71, s71, 1507328
    v_mov_b32 v27, s70
    s_barrier
    s_waitcnt vmcnt(3)
    buffer_load_dwordx4 v[116:119], v2, s[28:31], s36 offen offset:0 nt
    buffer_load_dwordx4 v[120:123], v2, s[28:31], s36 offen offset:128 nt
    buffer_load_dwordx4 v[124:127], v2, s[28:31], s36 offen offset:256 nt
    s_add_u32 s34, s34, 98304
    s_add_u32 s35, s35, 39936
    s_sub_u32 s37, s35, 98304
    s_cselect_b32 s35, s35, s37
    s_add_u32 s36, s34, s35
    s_waitcnt vmcnt(3)
    buffer_load_dwordx4 v[128:131], v2, s[28:31], s36 offen offset:0 nt
    buffer_load_dwordx4 v[132:135], v2, s[28:31], s36 offen offset:128 nt
    buffer_load_dwordx4 v[136:139], v2, s[28:31], s36 offen offset:256 nt
    s_add_u32 s34, s34, 98304
    s_add_u32 s35, s35, 39936
    s_sub_u32 s37, s35, 98304
    s_cselect_b32 s35, s35, s37
    s_add_u32 s36, s34, s35
    s_waitcnt vmcnt(3)
    buffer_load_dwordx4 v[140:143], v2, s[28:31], s36 offen offset:0 nt
    buffer_load_dwordx4 v[144:147], v2, s[28:31], s36 offen offset:128 nt
    buffer_load_dwordx4 v[148:151], v2, s[28:31], s36 offen offset:256 nt
    s_add_u32 s34, s34, 98304
    s_add_u32 s35, s35, 39936
    s_sub_u32 s37, s35, 98304
    s_cselect_b32 s35, s35, s37
    s_add_u32 s36, s34, s35
    s_waitcnt vmcnt(3)
    buffer_load_dwordx4 v[152:155], v2, s[28:31], s36 offen offset:0 nt
    buffer_load_dwordx4 v[156:159], v2, s[28:31], s36 offen offset:128 nt
    buffer_load_dwordx4 v[160:163], v2, s[28:31], s36 offen offset:256 nt
    s_add_u32 s34, s34, 98304
    s_add_u32 s35, s35, 39936
    s_sub_u32 s37, s35, 98304
    s_cselect_b32 s35, s35, s37
    s_add_u32 s36, s34, s35
    s_waitcnt vmcnt(3)
    buffer_load_dwordx4 v[164:167], v2, s[28:31], s36 offen offset:0 nt
    buffer_load_dwordx4 v[168:171], v2, s[28:31], s36 offen offset:128 nt
    buffer_load_dwordx4 v[172:175], v2, s[28:31], s36 offen offset:256 nt
    s_add_u32 s34, s34, 98304
    s_add_u32 s35, s35, 39936
    s_sub_u32 s37, s35, 98304
    s_cselect_b32 s35, s35, s37
    s_add_u32 s36, s34, s35
    s_barrier
L_kq:
    ds_read_b128 v[60:63], v12 offset:0
    ds_read_b128 v[64:67], v12 offset:128
    ds_read_b128 v[68:71], v12 offset:256
    v_add_u32 v12, 384, v12
    s_waitcnt lgkmcnt(0)
L_k:
    s_and_b32 s39, s38, 3
    s_cmp_eq_u32 s39, 3
    s_cselect_b32 s44, 97517568, 0
    s_add_u32 s34, s34, s44
    s_add_u32 s36, s34, s35
    s_cmp_lg_u32 s38, 15
    s_cbranch_scc1 L_k1
    s_mov_b32 s28, s32
    s_mov_b32 s29, s33
    s_mov_b32 s34, 0
    s_mov_b32 s36, s35
    v_mov_b32 v2, v3
L_k1:
    v_mfma_f32_16x16x32_bf16 v[32:35], v[80:83], v[60:63], 0
    v_mfma_f32_16x16x32_bf16 v[32:35], v[84:87], v[64:67], v[32:35]
    v_mfma_f32_16x16x32_bf16 v[32:35], v[88:91], v[68:71], v[32:35]
    s_waitcnt vmcnt(7)
    s_cmp_ge_i32 s73, 0
    s_cbranch_scc1 L_nbk0
    s_add_u32 s73, s73, 1
    s_branch L_gok0
L_nbk0:
    s_waitcnt vmcnt(3)
    s_cmp_eq_u32 s73, 0
    s_cbranch_scc1 L_gok0
    s_sub_u32 s73, s73, 1
    s_waitcnt vmcnt(0)
L_gok0:
    s_mov_b64 exec, 1
    buffer_store_dword v27, v28, s[48:51], s71 offen
    s_mov_b64 exec, -1
    buffer_load_dwordx4 v[80:83], v2, s[28:31], s36 offen offset:0 nt
    buffer_load_dwordx4 v[84:87], v2, s[28:31], s36 offen offset:128 nt
    buffer_load_dwordx4 v[88:91], v2, s[28:31], s36 offen offset:256 nt
    s_add_u32 s34, s34, 98304
    s_add_u32 s35, s35, 39936
    s_sub_u32 s37, s35, 98304
    s_cselect_b32 s35, s35, s37
    s_add_u32 s36, s34, s35
    v_add_u32 v27, 1, v27
    s_cmp_eq_u32 s75, 0
    s_cbranch_scc1 L_onk0
    s_waitcnt vmcnt(4)
L_onk0:
    v_mfma_f32_16x16x32_bf16 v[36:39], v[92:95], v[60:63], 0
    v_mfma_f32_16x16x32_bf16 v[36:39], v[96:99], v[64:67], v[36:39]
    v_mfma_f32_16x16x32_bf16 v[36:39], v[100:103], v[68:71], v[36:39]
    s_waitcnt vmcnt(7)
    s_cmp_ge_i32 s73, 0
    s_cbranch_scc1 L_nbk1
    s_add_u32 s73, s73, 1
    s_branch L_gok1
L_nbk1:
    s_waitcnt vmcnt(4)
    s_cmp_eq_u32 s73, 0
    s_cbranch_scc1 L_gok1
    s_sub_u32 s73, s73, 1
    s_waitcnt vmcnt(0)
L_gok1:
    v_readfirstlane_b32 s72, v27
    buffer_load_dwordx3 v[24:26], v15, s[48:51], s71 offen nt
    buffer_load_dwordx4 v[92:95], v2, s[28:31], s36 offen offset:0 nt
    buffer_load_dwordx4 v[96:99], v2, s[28:31], s36 offen offset:128 nt
    buffer_load_dwordx4 v[100:103], v2, s[28:31], s36 offen offset:256 nt
    s_add_u32 s34, s34, 98304
    s_add_u32 s35, s35, 39936
    s_sub_u32 s37, s35, 98304
    s_cselect_b32 s35, s35, s37
    s_add_u32 s36, s34, s35
    v_add_u32 v27, 1, v27
    s_cmp_eq_u32 s75, 0
    s_cbranch_scc1 L_onk1
    s_waitcnt vmcnt(4)
L_onk1:
    v_mfma_f32_16x16x32_bf16 v[40:43], v[104:107], v[60:63], 0
    v_mfma_f32_16x16x32_bf16 v[40:43], v[108:111], v[64:67], v[40:43]
    v_mfma_f32_16x16x32_bf16 v[40:43], v[112:115], v[68:71], v[40:43]
    s_waitcnt vmcnt(8)
    s_cmp_ge_i32 s73, 0
    s_cbranch_scc1 L_nbk2
    s_add_u32 s73, s73, 1
    s_branch L_gok2
L_nbk2:
    s_waitcnt vmcnt(4)
    s_cmp_eq_u32 s73, 0
    s_cbranch_scc1 L_gok2
    s_sub_u32 s73, s73, 1
    s_waitcnt vmcnt(0)
L_gok2:
    s_mov_b64 exec, 1
    buffer_store_dword v27, v28, s[48:51], s71 offen
    s_mov_b64 exec, -1
    buffer_load_dwordx4 v[104:107], v2, s[28:31], s36 offen offset:0 nt
    buffer_load_dwordx4 v[108:111], v2, s[28:31], s36 offen offset:128 nt
    buffer_load_dwordx4 v[112:115], v2, s[28:31], s36 offen offset:256 nt
    s_add_u32 s34, s34, 98304
    s_add_u32 s35, s35, 39936
    s_sub_u32 s37, s35, 98304
    s_cselect_b32 s35, s35, s37
    s_add_u32 s36, s34, s35
    v_add_u32 v27, 1, v27
    s_cmp_eq_u32 s75, 0
    s_cbranch_scc1 L_onk2
    s_waitcnt vmcnt(4)
L_onk2:
    v_mfma_f32_16x16x32_bf16 v[44:47], v[116:119], v[60:63], 0
    v_mfma_f32_16x16x32_bf16 v[44:47], v[120:123], v[64:67], v[44:47]
    v_mfma_f32_16x16x32_bf16 v[44:47], v[124:127], v[68:71], v[44:47]
    s_waitcnt vmcnt(8)
    s_cmp_ge_i32 s73, 0
    s_cbranch_scc1 L_nbk3
    s_add_u32 s73, s73, 1
    s_branch L_gok3
L_nbk3:
    s_waitcnt vmcnt(4)
    s_cmp_eq_u32 s73, 0
    s_cbranch_scc1 L_gok3
    s_sub_u32 s73, s73, 1
    s_waitcnt vmcnt(0)
L_gok3:
    buffer_load_dwordx4 v[116:119], v2, s[28:31], s36 offen offset:0 nt
    buffer_load_dwordx4 v[120:123], v2, s[28:31], s36 offen offset:128 nt
    buffer_load_dwordx4 v[124:127], v2, s[28:31], s36 offen offset:256 nt
    s_add_u32 s34, s34, 98304
    s_add_u32 s35, s35, 39936
    s_sub_u32 s37, s35, 98304
    s_cselect_b32 s35, s35, s37
    s_add_u32 s36, s34, s35
    v_add_u32 v27, 1, v27
    s_cmp_eq_u32 s75, 0
    s_cbranch_scc1 L_onk3
    s_waitcnt vmcnt(3)
L_onk3:
    v_add_f32_dpp v16, v32, v33 quad_perm:[0,0,2,2] row_mask:0xf bank_mask:0x3
    v_add_f32_dpp v17, v36, v37 quad_perm:[0,0,2,2] row_mask:0xf bank_mask:0x3
    v_add_f32_dpp v18, v40, v41 quad_perm:[0,0,2,2] row_mask:0xf bank_mask:0x3
    v_add_f32_dpp v19, v44, v45 quad_perm:[0,0,2,2] row_mask:0xf bank_mask:0x3
    v_add_f32_dpp v16, v34, v35 quad_perm:[0,0,2,2] row_mask:0xf bank_mask:0xc
    v_add_f32_dpp v17, v38, v39 quad_perm:[0,0,2,2] row_mask:0xf bank_mask:0xc
    v_add_f32_dpp v18, v42, v43 quad_perm:[0,0,2,2] row_mask:0xf bank_mask:0xc
    v_add_f32_dpp v19, v46, v47 quad_perm:[0,0,2,2] row_mask:0xf bank_mask:0xc
    v_cvt_pk_bf16_f32 v20, v16, v17
    v_cvt_pk_bf16_f32 v21, v18, v19
    s_nop 0
    v_mov_b32_dpp v22, v20 quad_perm:[1,1,3,3] row_mask:0xf bank_mask:0xf
    v_mov_b32_dpp v23, v21 quad_perm:[1,1,3,3] row_mask:0xf bank_mask:0xf
    v_lshlrev_b32 v16, 16, v22
    v_and_b32 v17, v11, v22
    v_lshlrev_b32 v18, 16, v23
    v_and_b32 v19, v11, v23
    v_mul_f32 v16, s40, v16
    v_mul_f32 v17, s40, v17
    v_mul_f32 v18, s40, v18
    v_mul_f32 v19, s40, v19
    v_cvt_pk_bf16_f32 v20, v16, v17
    v_cvt_pk_bf16_f32 v21, v18, v19
    s_mov_b64 exec, s[46:47]
    ds_write_b64 v30, v[20:21] offset:0
    s_mov_b64 exec, -1
    v_lshlrev_b32 v16, 16, v20
    v_and_b32 v17, v11, v20
    v_lshlrev_b32 v18, 16, v21
    v_and_b32 v19, v11, v21
    v_max3_f32 v8, v8, v16, v17
    v_max3_f32 v8, v8, v18, v19
    v_mfma_f32_16x16x32_bf16 v[32:35], v[128:131], v[60:63], 0
    v_mfma_f32_16x16x32_bf16 v[32:35], v[132:135], v[64:67], v[32:35]
    v_mfma_f32_16x16x32_bf16 v[32:35], v[136:139], v[68:71], v[32:35]
    s_waitcnt vmcnt(7)
    v_readlane_b32 s66, v26, 63
    v_subrev_u32 v16, s70, v24
    v_subrev_u32 v17, s70, v25
    v_cmp_gt_u32 vcc, 0x200, v16
    v_cmp_gt_u32 s[68:69], s74, v17
    v_sub_u32 v24, s72, v24
    v_sub_u32 v25, s72, v25
    v_cndmask_b32 v24, 0, v24, vcc
    v_cndmask_b32 v25, 0, v25, s[68:69]
    v_add_u32 v24, v24, v25
    s_sub_u32 s66, s66, s70
    s_cmp_lt_u32 s66, 0x800
    s_cselect_b32 s66, s66, 0x400
    v_add_u32_dpp v24, v24, v24 row_ror:8 row_mask:0xf bank_mask:0xf
    s_nop 1
    v_add_u32_dpp v24, v24, v24 row_ror:4 row_mask:0xf bank_mask:0xf
    s_nop 1
    v_add_u32_dpp v24, v24, v24 row_ror:2 row_mask:0xf bank_mask:0xf
    s_nop 1
    v_add_u32_dpp v24, v24, v24 row_ror:1 row_mask:0xf bank_mask:0xf
    s_nop 0
    v_readlane_b32 s65, v24, 0
    v_readlane_b32 s67, v24, 16
    s_add_u32 s65, s65, s67
    v_readlane_b32 s67, v24, 32
    s_add_u32 s65, s65, s67
    v_readlane_b32 s67, v24, 48
    s_add_u32 s65, s65, s67
    s_add_u32 s65, s65, s66
    s_cmp_gt_i32 s65, 1536
    s_cselect_b32 s73, 2, 0
    s_cmp_lt_i32 s65, 1024
    s_cselect_b32 s73, -4, s73
    s_cmp_gt_i32 s65, 1280
    s_cselect_b32 s75, 1, 0
    s_cmp_ge_i32 s73, 0
    s_cbranch_scc1 L_nbk4
    s_add_u32 s73, s73, 1
    s_branch L_gok4
L_nbk4:
    s_waitcnt vmcnt(3)
    s_cmp_eq_u32 s73, 0
    s_cbranch_scc1 L_gok4
    s_sub_u32 s73, s73, 1
    s_waitcnt vmcnt(0)
L_gok4:
    s_mov_b64 exec, 1
    buffer_store_dword v27, v28, s[48:51], s71 offen
    s_mov_b64 exec, -1
    buffer_load_dwordx4 v[128:131], v2, s[28:31], s36 offen offset:0 nt
    buffer_load_dwordx4 v[132:135], v2, s[28:31], s36 offen offset:128 nt
    buffer_load_dwordx4 v[136:139], v2, s[28:31], s36 offen offset:256 nt
    s_add_u32 s34, s34, 98304
    s_add_u32 s35, s35, 39936
    s_sub_u32 s37, s35, 98304
    s_cselect_b32 s35, s35, s37
    s_add_u32 s36, s34, s35
    v_add_u32 v27, 1, v27
    s_cmp_eq_u32 s75, 0
    s_cbranch_scc1 L_onk4
    s_waitcnt vmcnt(4)
L_onk4:
    v_mfma_f32_16x16x32_bf16 v[36:39], v[140:143], v[60:63], 0
    v_mfma_f32_16x16x32_bf16 v[36:39], v[144:147], v[64:67], v[36:39]
    v_mfma_f32_16x16x32_bf16 v[36:39], v[148:151], v[68:71], v[36:39]
    s_waitcnt vmcnt(7)
    s_cmp_ge_i32 s73, 0
    s_cbranch_scc1 L_nbk5
    s_add_u32 s73, s73, 1
    s_branch L_gok5
L_nbk5:
    s_waitcnt vmcnt(4)
    s_cmp_eq_u32 s73, 0
    s_cbranch_scc1 L_gok5
    s_sub_u32 s73, s73, 1
    s_waitcnt vmcnt(0)
L_gok5:
    buffer_load_dwordx4 v[140:143], v2, s[28:31], s36 offen offset:0 nt
    buffer_load_dwordx4 v[144:147], v2, s[28:31], s36 offen offset:128 nt
    buffer_load_dwordx4 v[148:151], v2, s[28:31], s36 offen offset:256 nt
    s_add_u32 s34, s34, 98304
    s_add_u32 s35, s35, 39936
    s_sub_u32 s37, s35, 98304
    s_cselect_b32 s35, s35, s37
    s_add_u32 s36, s34, s35
    v_add_u32 v27, 1, v27
    s_cmp_eq_u32 s75, 0
    s_cbranch_scc1 L_onk5
    s_waitcnt vmcnt(3)
L_onk5:
    v_mfma_f32_16x16x32_bf16 v[40:43], v[152:155], v[60:63], 0
    v_mfma_f32_16x16x32_bf16 v[40:43], v[156:159], v[64:67], v[40:43]
    v_mfma_f32_16x16x32_bf16 v[40:43], v[160:163], v[68:71], v[40:43]
    s_waitcnt vmcnt(7)
    s_cmp_ge_i32 s73, 0
    s_cbranch_scc1 L_nbk6
    s_add_u32 s73, s73, 1
    s_branch L_gok6
L_nbk6:
    s_waitcnt vmcnt(3)
    s_cmp_eq_u32 s73, 0
    s_cbranch_scc1 L_gok6
    s_sub_u32 s73, s73, 1
    s_waitcnt vmcnt(0)
L_gok6:
    s_mov_b64 exec, 1
    buffer_store_dword v27, v28, s[48:51], s71 offen
    s_mov_b64 exec, -1
    buffer_load_dwordx4 v[152:155], v2, s[28:31], s36 offen offset:0 nt
    buffer_load_dwordx4 v[156:159], v2, s[28:31], s36 offen offset:128 nt
    buffer_load_dwordx4 v[160:163], v2, s[28:31], s36 offen offset:256 nt
    s_add_u32 s34, s34, 98304
    s_add_u32 s35, s35, 39936
    s_sub_u32 s37, s35, 98304
    s_cselect_b32 s35, s35, s37
    s_add_u32 s36, s34, s35
    v_add_u32 v27, 1, v27
    s_cmp_eq_u32 s75, 0
    s_cbranch_scc1 L_onk6
    s_waitcnt vmcnt(4)
L_onk6:
    v_mfma_f32_16x16x32_bf16 v[44:47], v[164:167], v[60:63], 0
    v_mfma_f32_16x16x32_bf16 v[44:47], v[168:171], v[64:67], v[44:47]
    v_mfma_f32_16x16x32_bf16 v[44:47], v[172:175], v[68:71], v[44:47]
    s_waitcnt vmcnt(7)
    s_cmp_ge_i32 s73, 0
    s_cbranch_scc1 L_nbk7
    s_add_u32 s73, s73, 1
    s_branch L_gok7
L_nbk7:
    s_waitcnt vmcnt(4)
    s_cmp_eq_u32 s73, 0
    s_cbranch_scc1 L_gok7
    s_sub_u32 s73, s73, 1
    s_waitcnt vmcnt(0)
L_gok7:
    buffer_load_dwordx4 v[164:167], v2, s[28:31], s36 offen offset:0 nt
    buffer_load_dwordx4 v[168:171], v2, s[28:31], s36 offen offset:128 nt
    buffer_load_dwordx4 v[172:175], v2, s[28:31], s36 offen offset:256 nt
    s_add_u32 s34, s34, 98304
    s_add_u32 s35, s35, 39936
    s_sub_u32 s37, s35, 98304
    s_cselect_b32 s35, s35, s37
    s_add_u32 s36, s34, s35
    v_add_u32 v27, 1, v27
    s_cmp_eq_u32 s75, 0
    s_cbranch_scc1 L_onk7
    s_waitcnt vmcnt(3)
L_onk7:
    v_add_f32_dpp v16, v32, v33 quad_perm:[0,0,2,2] row_mask:0xf bank_mask:0x3
    v_add_f32_dpp v17, v36, v37 quad_perm:[0,0,2,2] row_mask:0xf bank_mask:0x3
    v_add_f32_dpp v18, v40, v41 quad_perm:[0,0,2,2] row_mask:0xf bank_mask:0x3
    v_add_f32_dpp v19, v44, v45 quad_perm:[0,0,2,2] row_mask:0xf bank_mask:0x3
    v_add_f32_dpp v16, v34, v35 quad_perm:[0,0,2,2] row_mask:0xf bank_mask:0xc
    v_add_f32_dpp v17, v38, v39 quad_perm:[0,0,2,2] row_mask:0xf bank_mask:0xc
    v_add_f32_dpp v18, v42, v43 quad_perm:[0,0,2,2] row_mask:0xf bank_mask:0xc
    v_add_f32_dpp v19, v46, v47 quad_perm:[0,0,2,2] row_mask:0xf bank_mask:0xc
    v_cvt_pk_bf16_f32 v20, v16, v17
    v_cvt_pk_bf16_f32 v21, v18, v19
    s_nop 0
    v_mov_b32_dpp v22, v20 quad_perm:[1,1,3,3] row_mask:0xf bank_mask:0xf
    v_mov_b32_dpp v23, v21 quad_perm:[1,1,3,3] row_mask:0xf bank_mask:0xf
    v_lshlrev_b32 v16, 16, v22
    v_and_b32 v17, v11, v22
    v_lshlrev_b32 v18, 16, v23
    v_and_b32 v19, v11, v23
    v_mul_f32 v16, s40, v16
    v_mul_f32 v17, s40, v17
    v_mul_f32 v18, s40, v18
    v_mul_f32 v19, s40, v19
    v_cvt_pk_bf16_f32 v20, v16, v17
    v_cvt_pk_bf16_f32 v21, v18, v19
    s_mov_b64 exec, s[46:47]
    ds_write_b64 v30, v[20:21] offset:64
    s_mov_b64 exec, -1
    v_lshlrev_b32 v16, 16, v20
    v_and_b32 v17, v11, v20
    v_lshlrev_b32 v18, 16, v21
    v_and_b32 v19, v11, v21
    v_max3_f32 v8, v8, v16, v17
    v_max3_f32 v8, v8, v18, v19
    v_add_u32 v30, 128, v30
    s_add_u32 s38, s38, 1
    s_cmp_lg_u32 s39, 3
    s_cbranch_scc1 L_k
    v_max_f32_dpp v8, v8, v8 row_ror:8 row_mask:0xf bank_mask:0xf
    v_mov_b32 v22, v8
    s_nop 1
    v_permlane16_swap_b32 v8, v22
    v_max_f32 v8, v8, v22
    v_mov_b32 v22, v8
    s_nop 1
    v_permlane32_swap_b32 v8, v22
    v_max_f32 v8, v8, v22
    ds_write_b32 v31, v8
    v_add_u32 v31, 16, v31
    v_mov_b32 v8, 0xff800000
    s_cmp_lg_u32 s38, 16
    s_cbranch_scc1 L_kq
    v_subrev_u32 v30, 2048, v30
    v_subrev_u32 v31, 64, v31
L_vb:
    ds_read_b32 v10, v31
    v_add_u32 v31, 16, v31
L_v:
    v_mov_b32 v9, s38
    ds_write_b32 v29, v9 offset:10112
    ds_read2_b64 v[20:23], v30 offset0:0 offset1:8
    v_add_u32 v30, 128, v30
    s_and_b32 s39, s38, 3
    s_cmp_eq_u32 s39, 3
    s_cselect_b32 s44, 97517568, 0
    s_add_u32 s34, s34, s44
    s_add_u32 s36, s34, s35
    s_waitcnt lgkmcnt(0)
    v_lshlrev_b32 v32, 16, v20
    v_and_b32 v33, v11, v20
    v_lshlrev_b32 v34, 16, v21
    v_and_b32 v35, v11, v21
    v_lshlrev_b32 v36, 16, v22
    v_and_b32 v37, v11, v22
    v_lshlrev_b32 v38, 16, v23
    v_and_b32 v39, v11, v23
    v_sub_f32 v32, v32, v10
    v_sub_f32 v33, v33, v10
    v_sub_f32 v34, v34, v10
    v_sub_f32 v35, v35, v10
    v_sub_f32 v36, v36, v10
    v_sub_f32 v37, v37, v10
    v_sub_f32 v38, v38, v10
    v_sub_f32 v39, v39, v10
    v_mul_f32 v32, s41, v32
    v_mul_f32 v33, s41, v33
    v_mul_f32 v34, s41, v34
    v_mul_f32 v35, s41, v35
    v_mul_f32 v36, s41, v36
    v_mul_f32 v37, s41, v37
    v_mul_f32 v38, s41, v38
    v_mul_f32 v39, s41, v39
    v_exp_f32 v32, v32
    v_exp_f32 v33, v33
    v_exp_f32 v34, v34
    v_exp_f32 v35, v35
    v_exp_f32 v36, v36
    v_exp_f32 v37, v37
    v_exp_f32 v38, v38
    v_exp_f32 v39, v39
    v_cvt_pk_bf16_f32 v40, v32, v32
    v_cvt_pk_bf16_f32 v41, v33, v33
    v_cvt_pk_bf16_f32 v42, v34, v34
    v_cvt_pk_bf16_f32 v43, v35, v35
    v_cvt_pk_bf16_f32 v44, v36, v36
    v_cvt_pk_bf16_f32 v45, v37, v37
    v_cvt_pk_bf16_f32 v46, v38, v38
    v_cvt_pk_bf16_f32 v47, v39, v39
    v_and_b32 v72, v40, v4
    v_and_b32 v73, v40, v5
    v_and_b32 v74, v40, v6
    v_and_b32 v75, v40, v7
    v_and_b32 v76, v41, v4
    v_and_b32 v77, v41, v5
    v_and_b32 v78, v41, v6
    v_and_b32 v79, v41, v7
    v_mfma_f32_16x16x32_bf16 v[48:51], v[72:75], v[80:83], v[48:51]
    v_mfma_f32_16x16x32_bf16 v[52:55], v[72:75], v[84:87], v[52:55]
    v_mfma_f32_16x16x32_bf16 v[56:59], v[72:75], v[88:91], v[56:59]
    s_cmp_eq_u32 s38, 31
    s_cbranch_scc1 L_last0
    s_waitcnt vmcnt(7)
    s_cmp_ge_i32 s73, 0
    s_cbranch_scc1 L_nbv0
    s_add_u32 s73, s73, 1
    s_branch L_gov0
L_nbv0:
    s_waitcnt vmcnt(3)
    s_cmp_eq_u32 s73, 0
    s_cbranch_scc1 L_gov0
    s_sub_u32 s73, s73, 1
    s_waitcnt vmcnt(0)
L_gov0:
    s_mov_b64 exec, 1
    buffer_store_dword v27, v28, s[48:51], s71 offen
    s_mov_b64 exec, -1
    buffer_load_dwordx4 v[80:83], v2, s[28:31], s36 offen offset:0 nt
    buffer_load_dwordx4 v[84:87], v2, s[28:31], s36 offen offset:128 nt
    buffer_load_dwordx4 v[88:91], v2, s[28:31], s36 offen offset:256 nt
    s_add_u32 s34, s34, 98304
    s_add_u32 s35, s35, 39936
    s_sub_u32 s37, s35, 98304
    s_cselect_b32 s35, s35, s37
    s_add_u32 s36, s34, s35
    v_add_u32 v27, 1, v27
    s_cmp_eq_u32 s75, 0
    s_cbranch_scc1 L_onv0
    s_waitcnt vmcnt(4)
L_onv0:
L_last0:
    v_and_b32 v72, v42, v4
    v_and_b32 v73, v42, v5
    v_and_b32 v74, v42, v6
    v_and_b32 v75, v42, v7
    v_mfma_f32_16x16x32_bf16 v[48:51], v[76:79], v[92:95], v[48:51]
    v_mfma_f32_16x16x32_bf16 v[52:55], v[76:79], v[96:99], v[52:55]
    v_mfma_f32_16x16x32_bf16 v[56:59], v[76:79], v[100:103], v[56:59]
    s_cmp_eq_u32 s38, 31
    s_cbranch_scc1 L_last1
    s_waitcnt vmcnt(7)
    s_cmp_ge_i32 s73, 0
    s_cbranch_scc1 L_nbv1
    s_add_u32 s73, s73, 1
    s_branch L_gov1
L_nbv1:
    s_waitcnt vmcnt(4)
    s_cmp_eq_u32 s73, 0
    s_cbranch_scc1 L_gov1
    s_sub_u32 s73, s73, 1
    s_waitcnt vmcnt(0)
L_gov1:
    v_readfirstlane_b32 s72, v27
    buffer_load_dwordx3 v[24:26], v15, s[48:51], s71 offen nt
    buffer_load_dwordx4 v[92:95], v2, s[28:31], s36 offen offset:0 nt
    buffer_load_dwordx4 v[96:99], v2, s[28:31], s36 offen offset:128 nt
    buffer_load_dwordx4 v[100:103], v2, s[28:31], s36 offen offset:256 nt
    s_add_u32 s34, s34, 98304
    s_add_u32 s35, s35, 39936
    s_sub_u32 s37, s35, 98304
    s_cselect_b32 s35, s35, s37
    s_add_u32 s36, s34, s35
    v_add_u32 v27, 1, v27
    s_cmp_eq_u32 s75, 0
    s_cbranch_scc1 L_onv1
    s_waitcnt vmcnt(4)
L_onv1:
L_last1:
    v_and_b32 v76, v43, v4
    v_and_b32 v77, v43, v5
    v_and_b32 v78, v43, v6
    v_and_b32 v79, v43, v7
    v_mfma_f32_16x16x32_bf16 v[48:51], v[72:75], v[104:107], v[48:51]
    v_mfma_f32_16x16x32_bf16 v[52:55], v[72:75], v[108:111], v[52:55]
    v_mfma_f32_16x16x32_bf16 v[56:59], v[72:75], v[112:115], v[56:59]
    s_cmp_eq_u32 s38, 31
    s_cbranch_scc1 L_last2
    s_waitcnt vmcnt(8)
    s_cmp_ge_i32 s73, 0
    s_cbranch_scc1 L_nbv2
    s_add_u32 s73, s73, 1
    s_branch L_gov2
L_nbv2:
    s_waitcnt vmcnt(4)
    s_cmp_eq_u32 s73, 0
    s_cbranch_scc1 L_gov2
    s_sub_u32 s73, s73, 1
    s_waitcnt vmcnt(0)
L_gov2:
    s_mov_b64 exec, 1
    buffer_store_dword v27, v28, s[48:51], s71 offen
    s_mov_b64 exec, -1
    buffer_load_dwordx4 v[104:107], v2, s[28:31], s36 offen offset:0 nt
    buffer_load_dwordx4 v[108:111], v2, s[28:31], s36 offen offset:128 nt
    buffer_load_dwordx4 v[112:115], v2, s[28:31], s36 offen offset:256 nt
    s_add_u32 s34, s34, 98304
    s_add_u32 s35, s35, 39936
    s_sub_u32 s37, s35, 98304
    s_cselect_b32 s35, s35, s37
    s_add_u32 s36, s34, s35
    v_add_u32 v27, 1, v27
    s_cmp_eq_u32 s75, 0
    s_cbranch_scc1 L_onv2
    s_waitcnt vmcnt(4)
L_onv2:
L_last2:
    v_and_b32 v72, v44, v4
    v_and_b32 v73, v44, v5
    v_and_b32 v74, v44, v6
    v_and_b32 v75, v44, v7
    v_mfma_f32_16x16x32_bf16 v[48:51], v[76:79], v[116:119], v[48:51]
    v_mfma_f32_16x16x32_bf16 v[52:55], v[76:79], v[120:123], v[52:55]
    v_mfma_f32_16x16x32_bf16 v[56:59], v[76:79], v[124:127], v[56:59]
    s_cmp_eq_u32 s38, 31
    s_cbranch_scc1 L_last3
    s_waitcnt vmcnt(8)
    s_cmp_ge_i32 s73, 0
    s_cbranch_scc1 L_nbv3
    s_add_u32 s73, s73, 1
    s_branch L_gov3
L_nbv3:
    s_waitcnt vmcnt(4)
    s_cmp_eq_u32 s73, 0
    s_cbranch_scc1 L_gov3
    s_sub_u32 s73, s73, 1
    s_waitcnt vmcnt(0)
L_gov3:
    buffer_load_dwordx4 v[116:119], v2, s[28:31], s36 offen offset:0 nt
    buffer_load_dwordx4 v[120:123], v2, s[28:31], s36 offen offset:128 nt
    buffer_load_dwordx4 v[124:127], v2, s[28:31], s36 offen offset:256 nt
    s_add_u32 s34, s34, 98304
    s_add_u32 s35, s35, 39936
    s_sub_u32 s37, s35, 98304
    s_cselect_b32 s35, s35, s37
    s_add_u32 s36, s34, s35
    v_add_u32 v27, 1, v27
    s_cmp_eq_u32 s75, 0
    s_cbranch_scc1 L_onv3
    s_waitcnt vmcnt(3)
L_onv3:
    s_branch L_next3
L_last3:
    s_waitcnt vmcnt(9)
L_next3:
    v_and_b32 v76, v45, v4
    v_and_b32 v77, v45, v5
    v_and_b32 v78, v45, v6
    v_and_b32 v79, v45, v7
    v_mfma_f32_16x16x32_bf16 v[48:51], v[72:75], v[128:131], v[48:51]
    v_mfma_f32_16x16x32_bf16 v[52:55], v[72:75], v[132:135], v[52:55]
    v_mfma_f32_16x16x32_bf16 v[56:59], v[72:75], v[136:139], v[56:59]
    s_cmp_eq_u32 s38, 31
    s_cbranch_scc1 L_last4
    s_waitcnt vmcnt(7)
    v_readlane_b32 s66, v26, 63
    v_subrev_u32 v16, s70, v24
    v_subrev_u32 v17, s70, v25
    v_cmp_gt_u32 vcc, 0x200, v16
    v_cmp_gt_u32 s[68:69], s74, v17
    v_sub_u32 v24, s72, v24
    v_sub_u32 v25, s72, v25
    v_cndmask_b32 v24, 0, v24, vcc
    v_cndmask_b32 v25, 0, v25, s[68:69]
    v_add_u32 v24, v24, v25
    s_sub_u32 s66, s66, s70
    s_cmp_lt_u32 s66, 0x800
    s_cselect_b32 s66, s66, 0x400
    v_add_u32_dpp v24, v24, v24 row_ror:8 row_mask:0xf bank_mask:0xf
    s_nop 1
    v_add_u32_dpp v24, v24, v24 row_ror:4 row_mask:0xf bank_mask:0xf
    s_nop 1
    v_add_u32_dpp v24, v24, v24 row_ror:2 row_mask:0xf bank_mask:0xf
    s_nop 1
    v_add_u32_dpp v24, v24, v24 row_ror:1 row_mask:0xf bank_mask:0xf
    s_nop 0
    v_readlane_b32 s65, v24, 0
    v_readlane_b32 s67, v24, 16
    s_add_u32 s65, s65, s67
    v_readlane_b32 s67, v24, 32
    s_add_u32 s65, s65, s67
    v_readlane_b32 s67, v24, 48
    s_add_u32 s65, s65, s67
    s_add_u32 s65, s65, s66
    s_cmp_gt_i32 s65, 1536
    s_cselect_b32 s73, 2, 0
    s_cmp_lt_i32 s65, 1024
    s_cselect_b32 s73, -4, s73
    s_cmp_gt_i32 s65, 1216
    s_cselect_b32 s75, 1, 0
    s_cmp_ge_i32 s73, 0
    s_cbranch_scc1 L_nbv4
    s_add_u32 s73, s73, 1
    s_branch L_gov4
L_nbv4:
    s_waitcnt vmcnt(3)
    s_cmp_eq_u32 s73, 0
    s_cbranch_scc1 L_gov4
    s_sub_u32 s73, s73, 1
    s_waitcnt vmcnt(0)
L_gov4:
    s_mov_b64 exec, 1
    buffer_store_dword v27, v28, s[48:51], s71 offen
    s_mov_b64 exec, -1
    buffer_load_dwordx4 v[128:131], v2, s[28:31], s36 offen offset:0 nt
    buffer_load_dwordx4 v[132:135], v2, s[28:31], s36 offen offset:128 nt
    buffer_load_dwordx4 v[136:139], v2, s[28:31], s36 offen offset:256 nt
    s_add_u32 s34, s34, 98304
    s_add_u32 s35, s35, 39936
    s_sub_u32 s37, s35, 98304
    s_cselect_b32 s35, s35, s37
    s_add_u32 s36, s34, s35
    v_add_u32 v27, 1, v27
    s_cmp_eq_u32 s75, 0
    s_cbranch_scc1 L_onv4
    s_waitcnt vmcnt(4)
L_onv4:
    s_branch L_next4
L_last4:
    s_waitcnt vmcnt(6)
L_next4:
    v_and_b32 v72, v46, v4
    v_and_b32 v73, v46, v5
    v_and_b32 v74, v46, v6
    v_and_b32 v75, v46, v7
    v_mfma_f32_16x16x32_bf16 v[48:51], v[76:79], v[140:143], v[48:51]
    v_mfma_f32_16x16x32_bf16 v[52:55], v[76:79], v[144:147], v[52:55]
    v_mfma_f32_16x16x32_bf16 v[56:59], v[76:79], v[148:151], v[56:59]
    s_cmp_eq_u32 s38, 31
    s_cbranch_scc1 L_last5
    s_waitcnt vmcnt(7)
    s_cmp_ge_i32 s73, 0
    s_cbranch_scc1 L_nbv5
    s_add_u32 s73, s73, 1
    s_branch L_gov5
L_nbv5:
    s_waitcnt vmcnt(4)
    s_cmp_eq_u32 s73, 0
    s_cbranch_scc1 L_gov5
    s_sub_u32 s73, s73, 1
    s_waitcnt vmcnt(0)
L_gov5:
    buffer_load_dwordx4 v[140:143], v2, s[28:31], s36 offen offset:0 nt
    buffer_load_dwordx4 v[144:147], v2, s[28:31], s36 offen offset:128 nt
    buffer_load_dwordx4 v[148:151], v2, s[28:31], s36 offen offset:256 nt
    s_add_u32 s34, s34, 98304
    s_add_u32 s35, s35, 39936
    s_sub_u32 s37, s35, 98304
    s_cselect_b32 s35, s35, s37
    s_add_u32 s36, s34, s35
    v_add_u32 v27, 1, v27
    s_cmp_eq_u32 s75, 0
    s_cbranch_scc1 L_onv5
    s_waitcnt vmcnt(3)
L_onv5:
    s_branch L_next5
L_last5:
    s_waitcnt vmcnt(3)
L_next5:
    v_and_b32 v76, v47, v4
    v_and_b32 v77, v47, v5
    v_and_b32 v78, v47, v6
    v_and_b32 v79, v47, v7
    v_mfma_f32_16x16x32_bf16 v[48:51], v[72:75], v[152:155], v[48:51]
    v_mfma_f32_16x16x32_bf16 v[52:55], v[72:75], v[156:159], v[52:55]
    v_mfma_f32_16x16x32_bf16 v[56:59], v[72:75], v[160:163], v[56:59]
    s_cmp_eq_u32 s38, 31
    s_cbranch_scc1 L_last6
    s_waitcnt vmcnt(7)
    s_cmp_ge_i32 s73, 0
    s_cbranch_scc1 L_nbv6
    s_add_u32 s73, s73, 1
    s_branch L_gov6
L_nbv6:
    s_waitcnt vmcnt(3)
    s_cmp_eq_u32 s73, 0
    s_cbranch_scc1 L_gov6
    s_sub_u32 s73, s73, 1
    s_waitcnt vmcnt(0)
L_gov6:
    s_mov_b64 exec, 1
    buffer_store_dword v27, v28, s[48:51], s71 offen
    s_mov_b64 exec, -1
    buffer_load_dwordx4 v[152:155], v2, s[28:31], s36 offen offset:0 nt
    buffer_load_dwordx4 v[156:159], v2, s[28:31], s36 offen offset:128 nt
    buffer_load_dwordx4 v[160:163], v2, s[28:31], s36 offen offset:256 nt
    s_add_u32 s34, s34, 98304
    s_add_u32 s35, s35, 39936
    s_sub_u32 s37, s35, 98304
    s_cselect_b32 s35, s35, s37
    s_add_u32 s36, s34, s35
    v_add_u32 v27, 1, v27
    s_cmp_eq_u32 s75, 0
    s_cbranch_scc1 L_onv6
    s_waitcnt vmcnt(4)
L_onv6:
    s_branch L_next6
L_last6:
    s_waitcnt vmcnt(0)
L_next6:
    v_mfma_f32_16x16x32_bf16 v[48:51], v[76:79], v[164:167], v[48:51]
    v_mfma_f32_16x16x32_bf16 v[52:55], v[76:79], v[168:171], v[52:55]
    v_mfma_f32_16x16x32_bf16 v[56:59], v[76:79], v[172:175], v[56:59]
    s_cmp_eq_u32 s38, 31
    s_cbranch_scc1 L_last7
    s_waitcnt vmcnt(7)
    s_cmp_ge_i32 s73, 0
    s_cbranch_scc1 L_nbv7
    s_add_u32 s73, s73, 1
    s_branch L_gov7
L_nbv7:
    s_waitcnt vmcnt(4)
    s_cmp_eq_u32 s73, 0
    s_cbranch_scc1 L_gov7
    s_sub_u32 s73, s73, 1
    s_waitcnt vmcnt(0)
L_gov7:
    buffer_load_dwordx4 v[164:167], v2, s[28:31], s36 offen offset:0 nt
    buffer_load_dwordx4 v[168:171], v2, s[28:31], s36 offen offset:128 nt
    buffer_load_dwordx4 v[172:175], v2, s[28:31], s36 offen offset:256 nt
    s_add_u32 s34, s34, 98304
    s_add_u32 s35, s35, 39936
    s_sub_u32 s37, s35, 98304
    s_cselect_b32 s35, s35, s37
    s_add_u32 s36, s34, s35
    v_add_u32 v27, 1, v27
    s_cmp_eq_u32 s75, 0
    s_cbranch_scc1 L_onv7
    s_waitcnt vmcnt(3)
L_onv7:
L_last7:
    s_add_u32 s38, s38, 1
    s_cmp_lg_u32 s39, 3
    s_cbranch_scc1 L_v
    s_mov_b64 exec, s[42:43]
    ds_write_b128 v13, v[48:51] offset:0
    ds_write_b128 v13, v[52:55] offset:256
    ds_write_b128 v13, v[56:59] offset:512
    s_mov_b64 exec, -1
    s_waitcnt lgkmcnt(0)
    s_cmp_eq_u32 s38, 32
    s_cbranch_scc1 L_vdone
    v_add_u32 v13, 6144, v13
    v_mov_b32 v48, 0
    v_mov_b32 v49, 0
    v_mov_b32 v50, 0
    v_mov_b32 v51, 0
    v_mov_b32 v52, 0
    v_mov_b32 v53, 0
    v_mov_b32 v54, 0
    v_mov_b32 v55, 0
    v_mov_b32 v56, 0
    v_mov_b32 v57, 0
    v_mov_b32 v58, 0
    v_mov_b32 v59, 0
    s_branch L_vb
L_vdone:
    s_barrier
    s_mov_b32 s28, s3
    s_branch L_owner
L_done:
L_end:
    s_endpgm
.section .rodata,"a"
.p2align 6
.amdhsa_kernel parallel_sum__mha_block_cached__dense_activation_silu__decode_kernel
  .amdhsa_next_free_vgpr 176
  .amdhsa_next_free_sgpr 96
  .amdhsa_accum_offset 176
  .amdhsa_group_segment_fixed_size 0
  .amdhsa_kernarg_size 88
  .amdhsa_user_sgpr_count 2
  .amdhsa_user_sgpr_kernarg_segment_ptr 1
  .amdhsa_system_sgpr_workgroup_id_x 1
.end_amdhsa_kernel
```
